```python
import torch

def _softmax(x, axis=-1):
    return torch.softmax(x, dim=axis)
def _gelu(x):
    return torch.nn.functional.gelu(x, approximate="tanh")
def _silu(x):
    return torch.nn.functional.silu(x)
def _sigmoid(x):
    return torch.sigmoid(x)
def _layernorm(x, axis=-1, eps=1e-5):
    m = x.mean(dim=axis, keepdim=True)
    v = x.var(dim=axis, keepdim=True, unbiased=False)
    return (x - m) / torch.sqrt(v + eps)
def _scatter_add(tgt, idx, src, axis=0):
    return tgt.clone().index_add_(axis, idx, src)
def _segment_sum(src, seg, n):
    out = torch.zeros((n,) + src.shape[1:], dtype=src.dtype)
    return out.index_add_(0, seg, src)
def _pad(x, pw):
    flat = tuple(v for pair in reversed(pw) for v in pair)
    return torch.nn.functional.pad(x, flat)

kernel_name = 'sequential_preLN__gqa_block_cached__glu_gated_geglu__decode'

def setup_inputs():

    _w = (lambda a: (lambda t: t.to(torch.bfloat16) if t.is_floating_point() else t)(torch.as_tensor(a)))
    def _A_setup():
        B, Sq, D = 1, 1, 640
        Hq, Hkv, Sk, Dh = 32, 32, 4096, 128
        assert Hq % Hkv == 0, (Hq, Hkv)
        return {
            "x": _w((lambda *s: torch.randn(*s, dtype=torch.bfloat16) * 0.05)(B, Sq, D)),
            "k_cache": _w((lambda *s: torch.randn(*s, dtype=torch.bfloat16) * 1.6)(B, Hkv, Sk, Dh)),
            "v_cache": _w((lambda *s: torch.randn(*s, dtype=torch.bfloat16) * 0.8)(B, Hkv, Sk, Dh)),
            "wq": _w((lambda *s: torch.randn(*s, dtype=torch.bfloat16) * 1.6)(D, Hq * Dh) * (D ** -0.5)),
            "wo": _w((lambda *s: torch.randn(*s, dtype=torch.bfloat16) * 0.8)(Hq * Dh, D) * ((Hq * Dh) ** -0.5)),
        }
    _A_in = _A_setup()

    def _B_setup():
        B, S, Dm, Df = 1, 1, 640, 1728
        return {
            "x": _w((lambda *s: torch.randn(*s, dtype=torch.bfloat16) * 0.05)(B, S, Dm)),
            "w_gate": _w((lambda *s: torch.randn(*s, dtype=torch.bfloat16) * 0.4)(Dm, Df) * (Dm ** -0.5)),
            "w_up": _w((lambda *s: torch.randn(*s, dtype=torch.bfloat16) * 0.4)(Dm, Df) * (Dm ** -0.5)),
            "w_down": _w((lambda *s: torch.randn(*s, dtype=torch.bfloat16) * 0.4)(Df, Dm) * (Df ** -0.5)),
        }
    _B_in = _B_setup()

    return {
        "A_x": _A_in["x"],
        "A_k_cache": _A_in["k_cache"],
        "A_v_cache": _A_in["v_cache"],
        "A_wq": _A_in["wq"],
        "A_wo": _A_in["wo"],
        "B_x": _B_in["x"],
        "B_w_gate": _B_in["w_gate"],
        "B_w_up": _B_in["w_up"],
        "B_w_down": _B_in["w_down"],
    }

def reference(A_x, A_k_cache, A_v_cache, A_wq, A_wo, B_x, B_w_gate, B_w_up, B_w_down):
    def _A_ref(x, k_cache, v_cache, wq, wo):
        B, Sq, D = x.shape
        Hq, Dh = 32, 128
        Hkv = k_cache.shape[1]
        rep = Hq // Hkv
        q = (lambda x, *d: x.permute(*d))((x @ wq).reshape(B, Sq, Hq, Dh), 0, 2, 1, 3)
        k = (lambda x, n, axis: torch.repeat_interleave(x, n, dim=axis))(k_cache, rep, axis=1)
        v = (lambda x, n, axis: torch.repeat_interleave(x, n, dim=axis))(v_cache, rep, axis=1)
        scores = torch.einsum("bhqd,bhkd->bhqk", q, k) * (Dh ** -0.5)
        p = _softmax(scores, axis=-1)
        o = torch.einsum("bhqk,bhkd->bhqd", p, v)
        return (lambda x, *d: x.permute(*d))(o, 0, 2, 1, 3).reshape(B, Sq, Hq * Dh) @ wo

    def _B_ref(x, w_gate, w_up, w_down):
        g = torch.einsum("bsd,df->bsf", x, w_gate)
        u = torch.einsum("bsd,df->bsf", x, w_up)
        h = _gelu(g) * u
        return torch.einsum("bsf,fd->bsd", h, w_down)

    x = A_x
    h = x + _A_ref(_layernorm(x, axis=-1), A_k_cache, A_v_cache, A_wq, A_wo)
    h2 = h + _B_ref(_layernorm(h, axis=-1), B_w_gate, B_w_up, B_w_down)
    return h2
```

```asm
; @launch grid=(256,1,1) block=(512,1,1) lds=46592
.amdgcn_target "amdgcn-amd-amdhsa--gfx950"
.text
.globl sequential_preLN__gqa_block_cached__glu_gated_geglu__decode_kernel
.p2align 8
.type sequential_preLN__gqa_block_cached__glu_gated_geglu__decode_kernel,@function
sequential_preLN__gqa_block_cached__glu_gated_geglu__decode_kernel:
s_cmp_ge_u32 s2, 256
s_cbranch_scc1 L_end
s_load_dwordx16 s[4:19], s[0:1], 0
s_load_dwordx8 s[20:27], s[0:1], 64
v_lshrrev_b32 v2, 6, v0
v_and_b32 v0, 63, v0
v_readfirstlane_b32 s3, v2
s_cmp_lt_u32 s2, 64
s_cbranch_scc1 L_aux
s_sub_u32 s36, s2, 64
s_mul_i32 s37, s36, 171
s_lshr_b32 s37, s37, 10
s_mul_i32 s38, s37, 6
s_sub_u32 s38, s36, s38
s_mul_i32 s39, s38, 43
s_cmp_eq_u32 s38, 5
s_cselect_b32 s40, 1, 0
s_sub_u32 s39, s39, s40
s_cmp_lt_u32 s38, 4
s_cselect_b32 s40, 3, 2
s_min_u32 s41, s3, s40
s_mul_i32 s42, s3, 5
s_add_u32 s39, s39, s41
s_add_u32 s39, s39, s42
s_cmp_lt_u32 s3, s40
s_cselect_b32 s41, 0, 1
s_cselect_b32 s43, 0, 2147483648
s_cselect_b32 s44, 0, 0xff800000
s_sub_u32 s39, s39, s41
s_lshl_b32 s39, s39, 12
s_lshl_b32 s42, s37, 20
s_add_u32 s39, s39, s42
v_bfe_u32 v2, v0, 2, 2
v_lshrrev_b32 v3, 4, v0
v_and_b32 v4, 3, v0
v_lshlrev_b32 v2, 8, v2
v_lshlrev_b32 v4, 4, v4
v_lshl_add_u32 v2, v3, 6, v2
v_add3_u32 v252, v2, v4, s39
v_and_b32 v4, 15, v0
v_lshlrev_b32 v3, 10, v3
v_lshlrev_b32 v4, 4, v4
v_add3_u32 v254, v3, v4, s39
v_or_b32 v253, s43, v252
v_or_b32 v255, s43, v254
v_mov_b32 v2, 0
v_mov_b32 v3, 0
v_lshlrev_b32 v4, 3, v0
ds_write_b64 v4, v[2:3] offset:5632
s_waitcnt lgkmcnt(0)
s_load_dword s84, s[26:27], 98304
s_mov_b32 s28, s6
s_mov_b32 s29, s7
s_mov_b32 s30, 33554432
s_mov_b32 s31, 0x20000
s_mov_b32 s32, s8
s_mov_b32 s33, s9
s_mov_b32 s34, 33554432
s_mov_b32 s35, 0x20000
s_mov_b32 s16, 4096
s_mov_b32 s17, 8192
s_mov_b32 s18, 12288
s_mov_b32 s19, 16384
s_mov_b32 s20, 20480
v_mov_b32 v248, v254
s_mov_b32 s12, s26
s_mov_b32 s13, s27
s_mov_b32 s14, 1211008
s_mov_b32 s15, 0x20000
buffer_load_dwordx4 v[16:19], v253, s[28:31], 0 offen offset:0 nt
buffer_load_dwordx4 v[20:23], v253, s[28:31], 0 offen offset:1024 nt
buffer_load_dwordx4 v[24:27], v253, s[28:31], 0 offen offset:2048 nt
buffer_load_dwordx4 v[28:31], v253, s[28:31], 0 offen offset:3072 nt
buffer_load_dwordx4 v[32:35], v252, s[28:31], s16 offen offset:0 nt
s_barrier
s_waitcnt vmcnt(4)
buffer_load_dwordx4 v[36:39], v252, s[28:31], s16 offen offset:1024 nt
s_waitcnt vmcnt(4)
buffer_load_dwordx4 v[40:43], v252, s[28:31], s16 offen offset:2048 nt
s_waitcnt vmcnt(4)
buffer_load_dwordx4 v[44:47], v252, s[28:31], s16 offen offset:3072 nt
s_waitcnt vmcnt(4)
buffer_load_dwordx4 v[48:51], v252, s[28:31], s17 offen offset:0 nt
s_waitcnt vmcnt(4)
buffer_load_dwordx4 v[52:55], v252, s[28:31], s17 offen offset:1024 nt
s_waitcnt vmcnt(4)
buffer_load_dwordx4 v[56:59], v252, s[28:31], s17 offen offset:2048 nt
s_waitcnt vmcnt(4)
buffer_load_dwordx4 v[60:63], v252, s[28:31], s17 offen offset:3072 nt
s_waitcnt vmcnt(4)
buffer_load_dwordx4 v[64:67], v252, s[28:31], s18 offen offset:0 nt
s_waitcnt vmcnt(4)
buffer_load_dwordx4 v[68:71], v252, s[28:31], s18 offen offset:1024 nt
s_waitcnt vmcnt(4)
buffer_load_dwordx4 v[72:75], v252, s[28:31], s18 offen offset:2048 nt
s_waitcnt vmcnt(4)
buffer_load_dwordx4 v[76:79], v252, s[28:31], s18 offen offset:3072 nt
s_waitcnt vmcnt(4)
buffer_load_dwordx4 v[80:83], v252, s[28:31], s19 offen offset:0 nt
s_waitcnt vmcnt(4)
buffer_load_dwordx4 v[84:87], v252, s[28:31], s19 offen offset:1024 nt
s_waitcnt vmcnt(4)
buffer_load_dwordx4 v[88:91], v252, s[28:31], s19 offen offset:2048 nt
s_waitcnt vmcnt(4)
buffer_load_dwordx4 v[92:95], v252, s[28:31], s19 offen offset:3072 nt
s_waitcnt vmcnt(4)
buffer_load_dwordx4 v[96:99], v252, s[28:31], s20 offen offset:0 nt
s_waitcnt vmcnt(4)
buffer_load_dwordx4 v[100:103], v252, s[28:31], s20 offen offset:1024 nt
s_waitcnt vmcnt(4)
buffer_load_dwordx4 v[104:107], v252, s[28:31], s20 offen offset:2048 nt
s_waitcnt vmcnt(4)
buffer_load_dwordx4 v[108:111], v252, s[28:31], s20 offen offset:3072 nt
s_waitcnt vmcnt(4)
buffer_load_dwordx4 v[112:115], v255, s[32:35], 0 offen offset:0 nt
s_waitcnt vmcnt(4)
buffer_load_dwordx4 v[116:119], v255, s[32:35], 0 offen offset:256 nt
s_waitcnt vmcnt(4)
buffer_load_dwordx4 v[120:123], v255, s[32:35], 0 offen offset:512 nt
s_waitcnt vmcnt(4)
buffer_load_dwordx4 v[124:127], v255, s[32:35], 0 offen offset:768 nt
s_waitcnt vmcnt(4)
buffer_load_dwordx4 v[128:131], v248, s[32:35], s16 offen offset:0 nt
s_waitcnt vmcnt(4)
buffer_load_dwordx4 v[132:135], v248, s[32:35], s16 offen offset:256 nt
s_waitcnt vmcnt(4)
buffer_load_dwordx4 v[136:139], v248, s[32:35], s16 offen offset:512 nt
s_waitcnt vmcnt(4)
buffer_load_dwordx4 v[140:143], v248, s[32:35], s16 offen offset:768 nt
s_waitcnt vmcnt(4)
s_cmp_lg_u32 s3, 7
s_cbranch_scc1 L_notrig32
s_waitcnt lgkmcnt(0)
s_or_b32 s22, s84, 0x01010101
s_add_u32 s22, s22, 1
s_or_b32 s22, s22, 0x01010101
s_sub_u32 s24, s2, 64
s_mul_i32 s23, s24, 171
s_lshr_b32 s23, s23, 9
s_mul_i32 s25, s23, 3
s_sub_u32 s24, s24, s25
s_cmp_ge_u32 s23, 37
s_cselect_b32 s25, 37, 0
s_sub_u32 s23, s23, s25
s_cmp_eq_u32 s25, 0
s_cselect_b32 s91, 9, 6
v_mov_b32 v2, s23
v_mad_u32_u24 v2, v0, s91, v2
s_cselect_b32 s91, 37, 27
v_subrev_u32 v3, s91, v2
v_min_u32 v2, v2, v3
v_add_u32 v2, s25, v2
v_lshlrev_b32 v2, 7, v2
v_mad_u32_u24 v3, v0, 12, v2
s_lshl_b32 s24, s24, 2
s_add_u32 s24, s24, 167552
v_add_u32 v3, s24, v3
v_mov_b32 v2, s22
s_mov_b64 exec, 15
buffer_store_dword v2, v3, s[12:15], 0 offen sc1
s_mov_b64 exec, -1
L_notrig32:
buffer_load_dwordx4 v[144:147], v248, s[32:35], s17 offen offset:0 nt
buffer_load_dwordx4 v[148:151], v248, s[32:35], s17 offen offset:256 nt
buffer_load_dwordx4 v[152:155], v248, s[32:35], s17 offen offset:512 nt
buffer_load_dwordx4 v[156:159], v248, s[32:35], s17 offen offset:768 nt
buffer_load_dwordx4 v[160:163], v248, s[32:35], s18 offen offset:0 nt
buffer_load_dwordx4 v[164:167], v248, s[32:35], s18 offen offset:256 nt
buffer_load_dwordx4 v[168:171], v248, s[32:35], s18 offen offset:512 nt
buffer_load_dwordx4 v[172:175], v248, s[32:35], s18 offen offset:768 nt
s_lshl_b32 s5, s36, 9
s_add_u32 s10, s26, s5
s_addc_u32 s11, s27, 0
s_mov_b32 s4, 0x100000
s_mov_b32 s5, s44
s_mul_i32 s6, s36, 640
s_add_u32 s6, s6, 178176
s_mul_i32 s7, s3, 544
s_mov_b32 s8, 0x3fb8aa3b
s_mov_b32 s9, 0x3db504f3
s_mov_b32 s21, 0xffff0000
v_and_b32 v2, 1, v0
v_lshlrev_b32 v2, 4, v2
v_mov_b32 v3, 0xffff
v_lshlrev_b32 v2, v2, v3
v_and_b32 v3, 15, v0
v_lshrrev_b32 v3, 1, v3
v_cmp_eq_u32 vcc, 0, v3
s_nop 1
v_cndmask_b32 v4, 0, v2, vcc
v_cmp_eq_u32 vcc, 1, v3
s_nop 1
v_cndmask_b32 v5, 0, v2, vcc
v_cmp_eq_u32 vcc, 2, v3
s_nop 1
v_cndmask_b32 v6, 0, v2, vcc
v_cmp_eq_u32 vcc, 3, v3
s_nop 1
v_cndmask_b32 v7, 0, v2, vcc
v_and_b32 v2, 15, v0
v_lshrrev_b32 v3, 4, v0
v_lshlrev_b32 v2, 5, v2
v_lshl_add_u32 v2, v3, 4, v2
v_add_u32 v2, s7, v2
v_lshlrev_b32 v3, 4, v0
v_add_u32 v3, 4352, v3
v_cmp_gt_u32 vcc, 32, v0
s_nop 1
v_cndmask_b32 v252, v3, v2, vcc
s_add_u32 s22, s7, 512
v_mov_b32 v2, s22
v_cmp_eq_u32 vcc, 0, v0
s_nop 1
v_cndmask_b32 v253, v3, v2, vcc
v_mov_b32 v3, 2147483648
v_and_b32 v2, 7, v0
v_mul_u32_u24 v255, 544, v2
v_cmp_gt_u32 vcc, 1, v2
v_mul_u32_u24 v14, 122880, v2
v_add_u32 v14, s6, v14
v_cndmask_b32 v14, v3, v14, vcc
v_lshrrev_b32 v2, 3, v0
v_lshlrev_b32 v2, 4, v2
v_add_u32 v15, v14, v2
v_add_u32 v15, 512, v15
v_cmp_gt_u32 vcc, 64, v0
s_nop 1
v_cndmask_b32 v15, v3, v15, vcc
s_lshl_b32 s22, s3, 7
v_add_u32 v2, s22, v2
v_add_u32 v254, v255, v2
v_add_u32 v14, v14, v2
v_bfe_u32 v2, v0, 2, 2
v_lshrrev_b32 v3, 4, v0
v_and_b32 v8, 3, v0
v_lshlrev_b32 v3, 6, v3
v_lshl_add_u32 v3, v8, 4, v3
v_mov_b32 v12, 256
v_cmp_eq_u32 vcc, 0, v2
s_nop 1
v_cndmask_b32 v8, v12, v3, vcc
v_cmp_eq_u32 vcc, 1, v2
s_nop 1
v_cndmask_b32 v9, v12, v3, vcc
v_cmp_eq_u32 vcc, 2, v2
s_nop 1
v_cndmask_b32 v10, v12, v3, vcc
v_cmp_eq_u32 vcc, 3, v2
s_nop 1
v_cndmask_b32 v11, v12, v3, vcc
s_waitcnt lgkmcnt(0)
s_or_b32 s84, s84, 0x01010101
s_add_u32 s84, s84, 1
s_or_b32 s84, s84, 0x01010101
s_and_b32 s85, s84, 0xff
s_bfe_u32 s86, s84, 0x80008
s_bfe_u32 s87, s84, 0x80010
s_lshr_b32 s88, s84, 24
s_cmp_lg_u32 s3, 0
s_cbranch_scc1 L_qwait
L_q0:
s_load_dwordx16 s[36:51], s[10:11], 0 glc
s_load_dwordx16 s[52:67], s[10:11], 64 glc
s_load_dwordx16 s[68:83], s[10:11], 128 glc
s_waitcnt lgkmcnt(0)
s_xor_b32 s22, s39, s84
s_xor_b32 s23, s43, s84
s_or_b32 s22, s22, s23
s_xor_b32 s23, s47, s84
s_or_b32 s22, s22, s23
s_xor_b32 s23, s51, s84
s_or_b32 s22, s22, s23
s_xor_b32 s23, s55, s84
s_or_b32 s22, s22, s23
s_xor_b32 s23, s59, s84
s_or_b32 s22, s22, s23
s_xor_b32 s23, s63, s84
s_or_b32 s22, s22, s23
s_xor_b32 s23, s67, s84
s_or_b32 s22, s22, s23
s_xor_b32 s23, s71, s84
s_or_b32 s22, s22, s23
s_xor_b32 s23, s75, s84
s_or_b32 s22, s22, s23
s_xor_b32 s23, s79, s84
s_or_b32 s22, s22, s23
s_cbranch_scc0 L_q0ok
s_sub_u32 s4, s4, 1
s_cbranch_scc0 L_q0
s_mov_b32 s4, 0
L_q0ok:
v_writelane_b32 v2, s36, 0
v_writelane_b32 v2, s37, 1
v_writelane_b32 v2, s38, 2
v_writelane_b32 v2, s40, 3
v_writelane_b32 v2, s41, 4
v_writelane_b32 v2, s42, 5
v_writelane_b32 v2, s44, 6
v_writelane_b32 v2, s45, 7
v_writelane_b32 v2, s46, 8
v_writelane_b32 v2, s48, 9
v_writelane_b32 v2, s49, 10
v_writelane_b32 v2, s50, 11
v_writelane_b32 v2, s52, 12
v_writelane_b32 v2, s53, 13
v_writelane_b32 v2, s54, 14
v_writelane_b32 v2, s56, 15
v_writelane_b32 v2, s57, 16
v_writelane_b32 v2, s58, 17
v_writelane_b32 v2, s60, 18
v_writelane_b32 v2, s61, 19
v_writelane_b32 v2, s62, 20
v_writelane_b32 v2, s64, 21
v_writelane_b32 v2, s65, 22
v_writelane_b32 v2, s66, 23
v_writelane_b32 v2, s68, 24
v_writelane_b32 v2, s69, 25
v_writelane_b32 v2, s70, 26
v_writelane_b32 v2, s72, 27
v_writelane_b32 v2, s73, 28
v_writelane_b32 v2, s74, 29
v_writelane_b32 v2, s76, 30
v_writelane_b32 v2, s77, 31
L_q1:
s_load_dwordx16 s[36:51], s[10:11], 256 glc
s_load_dwordx16 s[52:67], s[10:11], 320 glc
s_load_dwordx16 s[68:83], s[10:11], 384 glc
s_waitcnt lgkmcnt(0)
s_xor_b32 s22, s39, s84
s_xor_b32 s23, s43, s84
s_or_b32 s22, s22, s23
s_xor_b32 s23, s47, s84
s_or_b32 s22, s22, s23
s_xor_b32 s23, s51, s84
s_or_b32 s22, s22, s23
s_xor_b32 s23, s55, s84
s_or_b32 s22, s22, s23
s_xor_b32 s23, s59, s84
s_or_b32 s22, s22, s23
s_xor_b32 s23, s63, s84
s_or_b32 s22, s22, s23
s_xor_b32 s23, s67, s84
s_or_b32 s22, s22, s23
s_xor_b32 s23, s71, s84
s_or_b32 s22, s22, s23
s_xor_b32 s23, s75, s84
s_or_b32 s22, s22, s23
s_xor_b32 s23, s79, s84
s_or_b32 s22, s22, s23
s_cbranch_scc0 L_q1ok
s_sub_u32 s4, s4, 1
s_cbranch_scc0 L_q1
s_mov_b32 s4, 0
L_q1ok:
v_writelane_b32 v2, s36, 32
v_writelane_b32 v2, s37, 33
v_writelane_b32 v2, s38, 34
v_writelane_b32 v2, s40, 35
v_writelane_b32 v2, s41, 36
v_writelane_b32 v2, s42, 37
v_writelane_b32 v2, s44, 38
v_writelane_b32 v2, s45, 39
v_writelane_b32 v2, s46, 40
v_writelane_b32 v2, s48, 41
v_writelane_b32 v2, s49, 42
v_writelane_b32 v2, s50, 43
v_writelane_b32 v2, s52, 44
v_writelane_b32 v2, s53, 45
v_writelane_b32 v2, s54, 46
v_writelane_b32 v2, s56, 47
v_writelane_b32 v2, s57, 48
v_writelane_b32 v2, s58, 49
v_writelane_b32 v2, s60, 50
v_writelane_b32 v2, s61, 51
v_writelane_b32 v2, s62, 52
v_writelane_b32 v2, s64, 53
v_writelane_b32 v2, s65, 54
v_writelane_b32 v2, s66, 55
v_writelane_b32 v2, s68, 56
v_writelane_b32 v2, s69, 57
v_writelane_b32 v2, s70, 58
v_writelane_b32 v2, s72, 59
v_writelane_b32 v2, s73, 60
v_writelane_b32 v2, s74, 61
v_writelane_b32 v2, s76, 62
v_writelane_b32 v2, s77, 63
v_lshlrev_b32 v3, 2, v0
v_mov_b32 v13, 1
ds_write_b32 v3, v2 offset:5632
ds_write_b32 v12, v13 offset:5648
L_qwait:
ds_read_b32 v13, v12 offset:5648
s_waitcnt lgkmcnt(0)
v_cmp_eq_u32 vcc, 1, v13
s_cbranch_vccnz L_qgo
s_sleep 2
s_sub_u32 s4, s4, 1
s_cbranch_scc0 L_qwait
s_mov_b32 s4, 0
L_qgo:
ds_read_b128 v[208:211], v8 offset:5632
ds_read_b128 v[212:215], v9 offset:5632
ds_read_b128 v[216:219], v10 offset:5632
ds_read_b128 v[220:223], v11 offset:5632
s_waitcnt lgkmcnt(0)
s_waitcnt vmcnt(36)
v_mfma_f32_16x16x32_bf16 v[224:227], v[208:211], v[16:19], 0
v_mfma_f32_16x16x32_bf16 v[224:227], v[212:215], v[20:23], v[224:227]
v_mfma_f32_16x16x32_bf16 v[224:227], v[216:219], v[24:27], v[224:227]
v_mfma_f32_16x16x32_bf16 v[224:227], v[220:223], v[28:31], v[224:227]
s_waitcnt vmcnt(32)
v_mfma_f32_16x16x32_bf16 v[228:231], v[208:211], v[32:35], 0
v_mfma_f32_16x16x32_bf16 v[228:231], v[212:215], v[36:39], v[228:231]
v_mfma_f32_16x16x32_bf16 v[228:231], v[216:219], v[40:43], v[228:231]
v_mfma_f32_16x16x32_bf16 v[228:231], v[220:223], v[44:47], v[228:231]
s_waitcnt vmcnt(28)
v_mfma_f32_16x16x32_bf16 v[232:235], v[208:211], v[48:51], 0
v_mfma_f32_16x16x32_bf16 v[232:235], v[212:215], v[52:55], v[232:235]
v_mfma_f32_16x16x32_bf16 v[232:235], v[216:219], v[56:59], v[232:235]
v_mfma_f32_16x16x32_bf16 v[232:235], v[220:223], v[60:63], v[232:235]
s_waitcnt vmcnt(24)
v_mfma_f32_16x16x32_bf16 v[236:239], v[208:211], v[64:67], 0
v_mfma_f32_16x16x32_bf16 v[236:239], v[212:215], v[68:71], v[236:239]
v_mfma_f32_16x16x32_bf16 v[236:239], v[216:219], v[72:75], v[236:239]
v_mfma_f32_16x16x32_bf16 v[236:239], v[220:223], v[76:79], v[236:239]
s_waitcnt vmcnt(20)
v_mfma_f32_16x16x32_bf16 v[240:243], v[208:211], v[80:83], 0
v_mfma_f32_16x16x32_bf16 v[240:243], v[212:215], v[84:87], v[240:243]
v_mfma_f32_16x16x32_bf16 v[240:243], v[216:219], v[88:91], v[240:243]
v_mfma_f32_16x16x32_bf16 v[240:243], v[220:223], v[92:95], v[240:243]
s_waitcnt vmcnt(16)
v_mfma_f32_16x16x32_bf16 v[244:247], v[208:211], v[96:99], 0
v_mfma_f32_16x16x32_bf16 v[244:247], v[212:215], v[100:103], v[244:247]
v_mfma_f32_16x16x32_bf16 v[244:247], v[216:219], v[104:107], v[244:247]
v_mfma_f32_16x16x32_bf16 v[244:247], v[220:223], v[108:111], v[244:247]
v_mov_b32_dpp v8, v224 quad_perm:[0,0,0,0] row_mask:0xf bank_mask:0xf
v_mov_b32_dpp v9, v228 quad_perm:[0,0,0,0] row_mask:0xf bank_mask:0xf
v_mov_b32_dpp v10, v232 quad_perm:[0,0,0,0] row_mask:0xf bank_mask:0xf
v_mov_b32_dpp v11, v236 quad_perm:[0,0,0,0] row_mask:0xf bank_mask:0xf
v_mov_b32_dpp v12, v240 quad_perm:[0,0,0,0] row_mask:0xf bank_mask:0xf
s_nop 2
v_mov_b32_dpp v13, v244 quad_perm:[0,0,0,0] row_mask:0xf bank_mask:0xf
v_add_f32_dpp v8, v225, v8 quad_perm:[1,1,1,1] row_mask:0xf bank_mask:0xf
v_add_f32_dpp v9, v229, v9 quad_perm:[1,1,1,1] row_mask:0xf bank_mask:0xf
v_add_f32_dpp v10, v233, v10 quad_perm:[1,1,1,1] row_mask:0xf bank_mask:0xf
v_add_f32_dpp v11, v237, v11 quad_perm:[1,1,1,1] row_mask:0xf bank_mask:0xf
v_add_f32_dpp v12, v241, v12 quad_perm:[1,1,1,1] row_mask:0xf bank_mask:0xf
v_add_f32_dpp v13, v245, v13 quad_perm:[1,1,1,1] row_mask:0xf bank_mask:0xf
v_add_f32_dpp v8, v226, v8 quad_perm:[2,2,2,2] row_mask:0xf bank_mask:0xf
v_add_f32_dpp v9, v230, v9 quad_perm:[2,2,2,2] row_mask:0xf bank_mask:0xf
v_add_f32_dpp v10, v234, v10 quad_perm:[2,2,2,2] row_mask:0xf bank_mask:0xf
v_add_f32_dpp v11, v238, v11 quad_perm:[2,2,2,2] row_mask:0xf bank_mask:0xf
v_add_f32_dpp v12, v242, v12 quad_perm:[2,2,2,2] row_mask:0xf bank_mask:0xf
v_add_f32_dpp v13, v246, v13 quad_perm:[2,2,2,2] row_mask:0xf bank_mask:0xf
v_add_f32_dpp v8, v227, v8 quad_perm:[3,3,3,3] row_mask:0xf bank_mask:0xf
v_add_f32_dpp v9, v231, v9 quad_perm:[3,3,3,3] row_mask:0xf bank_mask:0xf
v_add_f32_dpp v10, v235, v10 quad_perm:[3,3,3,3] row_mask:0xf bank_mask:0xf
v_add_f32_dpp v11, v239, v11 quad_perm:[3,3,3,3] row_mask:0xf bank_mask:0xf
v_add_f32_dpp v12, v243, v12 quad_perm:[3,3,3,3] row_mask:0xf bank_mask:0xf
v_add_f32_dpp v13, v247, v13 quad_perm:[3,3,3,3] row_mask:0xf bank_mask:0xf
v_cvt_pk_bf16_f32 v208, v8, v9
v_cvt_pk_bf16_f32 v209, v10, v11
v_cvt_pk_bf16_f32 v210, v12, v13
v_lshlrev_b32 v8, 16, v208
v_and_b32 v9, s21, v208
v_lshlrev_b32 v10, 16, v209
v_and_b32 v11, s21, v209
v_lshlrev_b32 v12, 16, v210
v_and_b32 v13, s21, v210
v_mul_f32 v8, s9, v8
v_mul_f32 v9, s9, v9
v_mul_f32 v10, s9, v10
v_mul_f32 v11, s9, v11
v_mul_f32 v12, s9, v12
v_mul_f32 v13, s9, v13
v_cvt_pk_bf16_f32 v208, v8, v9
v_cvt_pk_bf16_f32 v209, v10, v11
v_cvt_pk_bf16_f32 v210, v12, v13
v_lshlrev_b32 v8, 16, v208
v_and_b32 v9, s21, v208
v_lshlrev_b32 v10, 16, v209
v_and_b32 v11, s21, v209
v_lshlrev_b32 v12, 16, v210
v_and_b32 v13, s21, v210
v_add_f32 v8, s5, v8
v_max3_f32 v212, v9, v10, v11
v_max3_f32 v214, v12, v13, v8
v_max_f32 v212, v212, v214
s_nop 1
v_max_f32_dpp v212, v212, v212 row_ror:4 row_mask:0xf bank_mask:0xf
s_nop 1
v_max_f32_dpp v212, v212, v212 row_ror:8 row_mask:0xf bank_mask:0xf
v_mov_b32 v214, v212
s_nop 1
v_permlane16_swap_b32 v212, v214
v_max_f32 v212, v212, v214
v_mov_b32 v214, v212
s_nop 1
v_permlane32_swap_b32 v212, v214
v_max_f32 v212, v212, v214
v_mul_f32 v212, s8, v212
v_fma_f32 v8, v8, s8, -v212
v_fma_f32 v9, v9, s8, -v212
v_fma_f32 v10, v10, s8, -v212
v_fma_f32 v11, v11, s8, -v212
v_fma_f32 v12, v12, s8, -v212
v_fma_f32 v13, v13, s8, -v212
v_exp_f32 v8, v8
v_exp_f32 v9, v9
v_exp_f32 v10, v10
v_exp_f32 v11, v11
v_exp_f32 v12, v12
v_exp_f32 v13, v13
v_cvt_pk_bf16_f32 v216, v8, v8
v_cvt_pk_bf16_f32 v217, v9, v9
v_cvt_pk_bf16_f32 v218, v10, v10
v_cvt_pk_bf16_f32 v219, v11, v11
v_cvt_pk_bf16_f32 v220, v12, v12
v_cvt_pk_bf16_f32 v221, v13, v13
v_and_b32_dpp v16, v216, v4 row_newbcast:0 row_mask:0xf bank_mask:0xf
v_and_b32_dpp v17, v216, v5 row_newbcast:0 row_mask:0xf bank_mask:0xf
v_and_b32_dpp v18, v216, v6 row_newbcast:0 row_mask:0xf bank_mask:0xf
v_and_b32_dpp v19, v216, v7 row_newbcast:0 row_mask:0xf bank_mask:0xf
v_and_b32_dpp v20, v216, v4 row_newbcast:4 row_mask:0xf bank_mask:0xf
v_and_b32_dpp v21, v216, v5 row_newbcast:4 row_mask:0xf bank_mask:0xf
v_and_b32_dpp v22, v216, v6 row_newbcast:4 row_mask:0xf bank_mask:0xf
v_and_b32_dpp v23, v216, v7 row_newbcast:4 row_mask:0xf bank_mask:0xf
v_and_b32_dpp v24, v216, v4 row_newbcast:8 row_mask:0xf bank_mask:0xf
v_and_b32_dpp v25, v216, v5 row_newbcast:8 row_mask:0xf bank_mask:0xf
v_and_b32_dpp v26, v216, v6 row_newbcast:8 row_mask:0xf bank_mask:0xf
v_and_b32_dpp v27, v216, v7 row_newbcast:8 row_mask:0xf bank_mask:0xf
v_and_b32_dpp v28, v216, v4 row_newbcast:12 row_mask:0xf bank_mask:0xf
v_and_b32_dpp v29, v216, v5 row_newbcast:12 row_mask:0xf bank_mask:0xf
v_and_b32_dpp v30, v216, v6 row_newbcast:12 row_mask:0xf bank_mask:0xf
v_and_b32_dpp v31, v216, v7 row_newbcast:12 row_mask:0xf bank_mask:0xf
v_and_b32_dpp v32, v217, v4 row_newbcast:0 row_mask:0xf bank_mask:0xf
v_and_b32_dpp v33, v217, v5 row_newbcast:0 row_mask:0xf bank_mask:0xf
v_and_b32_dpp v34, v217, v6 row_newbcast:0 row_mask:0xf bank_mask:0xf
v_and_b32_dpp v35, v217, v7 row_newbcast:0 row_mask:0xf bank_mask:0xf
v_and_b32_dpp v36, v217, v4 row_newbcast:4 row_mask:0xf bank_mask:0xf
v_and_b32_dpp v37, v217, v5 row_newbcast:4 row_mask:0xf bank_mask:0xf
v_and_b32_dpp v38, v217, v6 row_newbcast:4 row_mask:0xf bank_mask:0xf
v_and_b32_dpp v39, v217, v7 row_newbcast:4 row_mask:0xf bank_mask:0xf
v_and_b32_dpp v40, v217, v4 row_newbcast:8 row_mask:0xf bank_mask:0xf
v_and_b32_dpp v41, v217, v5 row_newbcast:8 row_mask:0xf bank_mask:0xf
v_and_b32_dpp v42, v217, v6 row_newbcast:8 row_mask:0xf bank_mask:0xf
v_and_b32_dpp v43, v217, v7 row_newbcast:8 row_mask:0xf bank_mask:0xf
v_and_b32_dpp v44, v217, v4 row_newbcast:12 row_mask:0xf bank_mask:0xf
v_and_b32_dpp v45, v217, v5 row_newbcast:12 row_mask:0xf bank_mask:0xf
v_and_b32_dpp v46, v217, v6 row_newbcast:12 row_mask:0xf bank_mask:0xf
v_and_b32_dpp v47, v217, v7 row_newbcast:12 row_mask:0xf bank_mask:0xf
v_and_b32_dpp v48, v218, v4 row_newbcast:0 row_mask:0xf bank_mask:0xf
v_and_b32_dpp v49, v218, v5 row_newbcast:0 row_mask:0xf bank_mask:0xf
v_and_b32_dpp v50, v218, v6 row_newbcast:0 row_mask:0xf bank_mask:0xf
v_and_b32_dpp v51, v218, v7 row_newbcast:0 row_mask:0xf bank_mask:0xf
v_and_b32_dpp v52, v218, v4 row_newbcast:4 row_mask:0xf bank_mask:0xf
v_and_b32_dpp v53, v218, v5 row_newbcast:4 row_mask:0xf bank_mask:0xf
v_and_b32_dpp v54, v218, v6 row_newbcast:4 row_mask:0xf bank_mask:0xf
v_and_b32_dpp v55, v218, v7 row_newbcast:4 row_mask:0xf bank_mask:0xf
v_and_b32_dpp v56, v218, v4 row_newbcast:8 row_mask:0xf bank_mask:0xf
v_and_b32_dpp v57, v218, v5 row_newbcast:8 row_mask:0xf bank_mask:0xf
v_and_b32_dpp v58, v218, v6 row_newbcast:8 row_mask:0xf bank_mask:0xf
v_and_b32_dpp v59, v218, v7 row_newbcast:8 row_mask:0xf bank_mask:0xf
v_and_b32_dpp v60, v218, v4 row_newbcast:12 row_mask:0xf bank_mask:0xf
v_and_b32_dpp v61, v218, v5 row_newbcast:12 row_mask:0xf bank_mask:0xf
v_and_b32_dpp v62, v218, v6 row_newbcast:12 row_mask:0xf bank_mask:0xf
v_and_b32_dpp v63, v218, v7 row_newbcast:12 row_mask:0xf bank_mask:0xf
v_and_b32_dpp v64, v219, v4 row_newbcast:0 row_mask:0xf bank_mask:0xf
v_and_b32_dpp v65, v219, v5 row_newbcast:0 row_mask:0xf bank_mask:0xf
v_and_b32_dpp v66, v219, v6 row_newbcast:0 row_mask:0xf bank_mask:0xf
v_and_b32_dpp v67, v219, v7 row_newbcast:0 row_mask:0xf bank_mask:0xf
v_and_b32_dpp v68, v219, v4 row_newbcast:4 row_mask:0xf bank_mask:0xf
v_and_b32_dpp v69, v219, v5 row_newbcast:4 row_mask:0xf bank_mask:0xf
v_and_b32_dpp v70, v219, v6 row_newbcast:4 row_mask:0xf bank_mask:0xf
v_and_b32_dpp v71, v219, v7 row_newbcast:4 row_mask:0xf bank_mask:0xf
v_and_b32_dpp v72, v219, v4 row_newbcast:8 row_mask:0xf bank_mask:0xf
v_and_b32_dpp v73, v219, v5 row_newbcast:8 row_mask:0xf bank_mask:0xf
v_and_b32_dpp v74, v219, v6 row_newbcast:8 row_mask:0xf bank_mask:0xf
v_and_b32_dpp v75, v219, v7 row_newbcast:8 row_mask:0xf bank_mask:0xf
v_and_b32_dpp v76, v219, v4 row_newbcast:12 row_mask:0xf bank_mask:0xf
v_and_b32_dpp v77, v219, v5 row_newbcast:12 row_mask:0xf bank_mask:0xf
v_and_b32_dpp v78, v219, v6 row_newbcast:12 row_mask:0xf bank_mask:0xf
v_and_b32_dpp v79, v219, v7 row_newbcast:12 row_mask:0xf bank_mask:0xf
v_and_b32_dpp v80, v220, v4 row_newbcast:0 row_mask:0xf bank_mask:0xf
v_and_b32_dpp v81, v220, v5 row_newbcast:0 row_mask:0xf bank_mask:0xf
v_and_b32_dpp v82, v220, v6 row_newbcast:0 row_mask:0xf bank_mask:0xf
v_and_b32_dpp v83, v220, v7 row_newbcast:0 row_mask:0xf bank_mask:0xf
v_and_b32_dpp v84, v220, v4 row_newbcast:4 row_mask:0xf bank_mask:0xf
v_and_b32_dpp v85, v220, v5 row_newbcast:4 row_mask:0xf bank_mask:0xf
v_and_b32_dpp v86, v220, v6 row_newbcast:4 row_mask:0xf bank_mask:0xf
v_and_b32_dpp v87, v220, v7 row_newbcast:4 row_mask:0xf bank_mask:0xf
v_and_b32_dpp v88, v220, v4 row_newbcast:8 row_mask:0xf bank_mask:0xf
v_and_b32_dpp v89, v220, v5 row_newbcast:8 row_mask:0xf bank_mask:0xf
v_and_b32_dpp v90, v220, v6 row_newbcast:8 row_mask:0xf bank_mask:0xf
v_and_b32_dpp v91, v220, v7 row_newbcast:8 row_mask:0xf bank_mask:0xf
v_and_b32_dpp v92, v220, v4 row_newbcast:12 row_mask:0xf bank_mask:0xf
v_and_b32_dpp v93, v220, v5 row_newbcast:12 row_mask:0xf bank_mask:0xf
v_and_b32_dpp v94, v220, v6 row_newbcast:12 row_mask:0xf bank_mask:0xf
v_and_b32_dpp v95, v220, v7 row_newbcast:12 row_mask:0xf bank_mask:0xf
v_and_b32_dpp v96, v221, v4 row_newbcast:0 row_mask:0xf bank_mask:0xf
v_and_b32_dpp v97, v221, v5 row_newbcast:0 row_mask:0xf bank_mask:0xf
v_and_b32_dpp v98, v221, v6 row_newbcast:0 row_mask:0xf bank_mask:0xf
v_and_b32_dpp v99, v221, v7 row_newbcast:0 row_mask:0xf bank_mask:0xf
v_and_b32_dpp v100, v221, v4 row_newbcast:4 row_mask:0xf bank_mask:0xf
v_and_b32_dpp v101, v221, v5 row_newbcast:4 row_mask:0xf bank_mask:0xf
v_and_b32_dpp v102, v221, v6 row_newbcast:4 row_mask:0xf bank_mask:0xf
v_and_b32_dpp v103, v221, v7 row_newbcast:4 row_mask:0xf bank_mask:0xf
v_and_b32_dpp v104, v221, v4 row_newbcast:8 row_mask:0xf bank_mask:0xf
v_and_b32_dpp v105, v221, v5 row_newbcast:8 row_mask:0xf bank_mask:0xf
v_and_b32_dpp v106, v221, v6 row_newbcast:8 row_mask:0xf bank_mask:0xf
v_and_b32_dpp v107, v221, v7 row_newbcast:8 row_mask:0xf bank_mask:0xf
v_and_b32_dpp v108, v221, v4 row_newbcast:12 row_mask:0xf bank_mask:0xf
v_and_b32_dpp v109, v221, v5 row_newbcast:12 row_mask:0xf bank_mask:0xf
v_and_b32_dpp v110, v221, v6 row_newbcast:12 row_mask:0xf bank_mask:0xf
v_and_b32_dpp v111, v221, v7 row_newbcast:12 row_mask:0xf bank_mask:0xf
v_add_f32 v213, v8, v9
v_add_f32 v214, v10, v11
v_add_f32 v12, v12, v13
v_add_f32 v213, v213, v214
v_add_f32 v213, v213, v12
s_nop 1
v_add_f32_dpp v213, v213, v213 row_ror:4 row_mask:0xf bank_mask:0xf
s_nop 1
v_add_f32_dpp v213, v213, v213 row_ror:8 row_mask:0xf bank_mask:0xf
v_mov_b32 v214, v213
s_nop 1
v_permlane16_swap_b32 v213, v214
v_add_f32 v213, v213, v214
v_mov_b32 v214, v213
s_nop 1
v_permlane32_swap_b32 v213, v214
v_add_f32 v213, v213, v214
ds_write_b64 v253, v[212:213]
buffer_load_dwordx4 v[176:179], v248, s[32:35], s19 offen offset:0 nt
buffer_load_dwordx4 v[180:183], v248, s[32:35], s19 offen offset:256 nt
buffer_load_dwordx4 v[184:187], v248, s[32:35], s19 offen offset:512 nt
buffer_load_dwordx4 v[188:191], v248, s[32:35], s19 offen offset:768 nt
buffer_load_dwordx4 v[192:195], v248, s[32:35], s20 offen offset:0 nt
buffer_load_dwordx4 v[196:199], v248, s[32:35], s20 offen offset:256 nt
buffer_load_dwordx4 v[200:203], v248, s[32:35], s20 offen offset:512 nt
buffer_load_dwordx4 v[204:207], v248, s[32:35], s20 offen offset:768 nt
s_waitcnt vmcnt(20)
v_mfma_f32_16x16x32_bf16 v[248:251], v[16:19], v[112:115], 0
v_mfma_f32_16x16x32_bf16 v[248:251], v[20:23], v[116:119], v[248:251]
v_mfma_f32_16x16x32_bf16 v[248:251], v[24:27], v[120:123], v[248:251]
v_mfma_f32_16x16x32_bf16 v[248:251], v[28:31], v[124:127], v[248:251]
s_waitcnt vmcnt(16)
v_mfma_f32_16x16x32_bf16 v[248:251], v[32:35], v[128:131], v[248:251]
v_mfma_f32_16x16x32_bf16 v[248:251], v[36:39], v[132:135], v[248:251]
v_mfma_f32_16x16x32_bf16 v[248:251], v[40:43], v[136:139], v[248:251]
v_mfma_f32_16x16x32_bf16 v[248:251], v[44:47], v[140:143], v[248:251]
s_waitcnt vmcnt(12)
v_mfma_f32_16x16x32_bf16 v[248:251], v[48:51], v[144:147], v[248:251]
v_mfma_f32_16x16x32_bf16 v[248:251], v[52:55], v[148:151], v[248:251]
v_mfma_f32_16x16x32_bf16 v[248:251], v[56:59], v[152:155], v[248:251]
v_mfma_f32_16x16x32_bf16 v[248:251], v[60:63], v[156:159], v[248:251]
s_waitcnt vmcnt(8)
v_mfma_f32_16x16x32_bf16 v[248:251], v[64:67], v[160:163], v[248:251]
v_mfma_f32_16x16x32_bf16 v[248:251], v[68:71], v[164:167], v[248:251]
v_mfma_f32_16x16x32_bf16 v[248:251], v[72:75], v[168:171], v[248:251]
v_mfma_f32_16x16x32_bf16 v[248:251], v[76:79], v[172:175], v[248:251]
s_waitcnt vmcnt(4)
v_mfma_f32_16x16x32_bf16 v[248:251], v[80:83], v[176:179], v[248:251]
v_mfma_f32_16x16x32_bf16 v[248:251], v[84:87], v[180:183], v[248:251]
v_mfma_f32_16x16x32_bf16 v[248:251], v[88:91], v[184:187], v[248:251]
v_mfma_f32_16x16x32_bf16 v[248:251], v[92:95], v[188:191], v[248:251]
s_waitcnt vmcnt(3)
v_mfma_f32_16x16x32_bf16 v[248:251], v[96:99], v[192:195], v[248:251]
s_waitcnt vmcnt(2)
v_mfma_f32_16x16x32_bf16 v[248:251], v[100:103], v[196:199], v[248:251]
s_waitcnt vmcnt(1)
v_mfma_f32_16x16x32_bf16 v[248:251], v[104:107], v[200:203], v[248:251]
s_waitcnt vmcnt(0)
v_mfma_f32_16x16x32_bf16 v[248:251], v[108:111], v[204:207], v[248:251]
s_nop 7
ds_write_b128 v252, v[248:251]
s_waitcnt lgkmcnt(0)
s_barrier
s_cmp_ge_u32 s3, 4
s_cbranch_scc1 L_att_end
L_comb:
ds_read_b64 v[16:17], v255 offset:512
ds_read_b128 v[20:23], v254
v_mov_b32 v26, s84
v_mov_b32 v27, s84
v_mov_b32 v18, 0xff
s_waitcnt lgkmcnt(1)
v_max_f32_dpp v24, v16, v16 quad_perm:[1,0,3,2] row_mask:0xf bank_mask:0xf
s_nop 1
v_max_f32_dpp v24, v24, v24 quad_perm:[2,3,0,1] row_mask:0xf bank_mask:0xf
s_nop 1
v_max_f32_dpp v24, v24, v24 row_half_mirror row_mask:0xf bank_mask:0xf
v_sub_f32 v16, v16, v24
v_exp_f32 v16, v16
s_waitcnt lgkmcnt(0)
v_mul_f32 v25, v16, v17
v_mul_f32 v20, v16, v20
v_mul_f32 v21, v16, v21
v_mul_f32 v22, v16, v22
v_mul_f32 v23, v16, v23
v_add_f32_dpp v20, v20, v20 quad_perm:[1,0,3,2] row_mask:0xf bank_mask:0xf
v_add_f32_dpp v21, v21, v21 quad_perm:[1,0,3,2] row_mask:0xf bank_mask:0xf
v_add_f32_dpp v22, v22, v22 quad_perm:[1,0,3,2] row_mask:0xf bank_mask:0xf
v_add_f32_dpp v23, v23, v23 quad_perm:[1,0,3,2] row_mask:0xf bank_mask:0xf
v_add_f32_dpp v25, v25, v25 quad_perm:[1,0,3,2] row_mask:0xf bank_mask:0xf
v_add_f32_dpp v20, v20, v20 quad_perm:[2,3,0,1] row_mask:0xf bank_mask:0xf
v_add_f32_dpp v21, v21, v21 quad_perm:[2,3,0,1] row_mask:0xf bank_mask:0xf
v_add_f32_dpp v22, v22, v22 quad_perm:[2,3,0,1] row_mask:0xf bank_mask:0xf
v_add_f32_dpp v23, v23, v23 quad_perm:[2,3,0,1] row_mask:0xf bank_mask:0xf
v_add_f32_dpp v25, v25, v25 quad_perm:[2,3,0,1] row_mask:0xf bank_mask:0xf
v_add_f32_dpp v20, v20, v20 row_half_mirror row_mask:0xf bank_mask:0xf
v_add_f32_dpp v21, v21, v21 row_half_mirror row_mask:0xf bank_mask:0xf
v_add_f32_dpp v22, v22, v22 row_half_mirror row_mask:0xf bank_mask:0xf
v_add_f32_dpp v23, v23, v23 row_half_mirror row_mask:0xf bank_mask:0xf
v_add_f32_dpp v25, v25, v25 row_half_mirror row_mask:0xf bank_mask:0xf
v_bfi_b32 v20, v18, s85, v20
v_bfi_b32 v21, v18, s86, v21
v_bfi_b32 v22, v18, s87, v22
v_bfi_b32 v23, v18, s88, v23
buffer_store_dwordx4 v[20:23], v14, s[12:15], 0 offen sc1
s_cmp_lg_u32 s3, 0
s_cbranch_scc1 L_comb_end
buffer_store_dwordx4 v[24:27], v15, s[12:15], 0 offen sc1
L_comb_end:
L_att_end:
L_end:
s_endpgm
L_aux:
v_lshrrev_b32 v2, 3, v0
v_and_b32 v3, 7, v0
s_mul_i32 s72, s3, 80
v_mul_u32_u24 v12, 10, v2
v_add_u32 v12, s72, v12
v_lshlrev_b32 v13, 2, v0
s_lshl_b32 s72, s3, 8
v_add_u32 v13, s72, v13
s_and_b32 s78, s2, 7
s_lshl_b32 s78, s78, 3
s_lshr_b32 s72, s2, 3
s_add_u32 s78, s78, s72
s_lshl_b32 s72, s78, 7
v_lshlrev_b32 v252, 13, v12
v_lshl_add_u32 v252, v3, 4, v252
v_add_u32 v252, s72, v252
v_mul_u32_u24 v254, 20, v0
v_lshlrev_b32 v255, 1, v12
s_mov_b32 s84, 8192
s_mov_b32 s85, 16384
s_mov_b32 s86, 24576
s_mov_b32 s87, 32768
s_mov_b32 s88, 40960
s_mov_b32 s89, 49152
s_mov_b32 s90, 57344
s_mov_b32 s91, 65536
s_mov_b32 s92, 73728
s_mul_i32 s74, s2, 37
s_lshr_b32 s74, s74, 8
s_mul_i32 s75, s74, 7
s_sub_u32 s75, s2, s75
s_lshl_b32 s76, s74, 3
s_sub_u32 s72, s2, 28
s_mul_i32 s73, s72, 86
s_lshr_b32 s73, s73, 8
s_mul_i32 s79, s73, 3
s_sub_u32 s72, s72, s79
s_add_u32 s72, s72, 7
s_mul_i32 s79, s73, 11
s_cmp_ge_u32 s2, 28
s_cselect_b32 s74, s73, s74
s_cselect_b32 s75, s72, s75
s_cselect_b32 s76, s79, s76
s_add_u32 s79, s76, 8
s_add_u32 s76, s76, s3
s_mul_i32 s72, s76, 163840
s_lshl_b32 s73, s75, 7
s_add_u32 s72, s72, s73
v_mul_u32_u24 v251, 20480, v2
v_lshl_add_u32 v251, v3, 4, v251
v_add_u32 v251, s72, v251
s_mov_b32 s69, 5120
s_mov_b32 s70, 10240
s_mov_b32 s71, 15360
s_sub_u32 s77, s2, 37
s_waitcnt lgkmcnt(0)
s_load_dword s93, s[26:27], 98304
s_mov_b32 s28, s4
s_mov_b32 s29, s5
s_mov_b32 s30, 1280
s_mov_b32 s31, 0x20000
s_mov_b32 s52, s10
s_mov_b32 s53, s11
s_mov_b32 s54, 5242880
s_mov_b32 s55, 0x20000
buffer_load_dwordx4 v[228:231], v254, s[28:31], 0 offen
buffer_load_dword v232, v254, s[28:31], 0 offen offset:16
buffer_load_dwordx4 v[236:239], v255, s[28:31], 0 offen
buffer_load_dword v233, v255, s[28:31], 0 offen offset:16
buffer_load_dword v200, v13, s[28:31], 0 offen
buffer_load_dwordx4 v[160:163], v252, s[52:55], 0 offen nt
buffer_load_dwordx4 v[164:167], v252, s[52:55], s84 offen nt
buffer_load_dwordx4 v[168:171], v252, s[52:55], s85 offen nt
buffer_load_dwordx4 v[172:175], v252, s[52:55], s86 offen nt
buffer_load_dwordx4 v[176:179], v252, s[52:55], s87 offen nt
buffer_load_dwordx4 v[180:183], v252, s[52:55], s88 offen nt
buffer_load_dwordx4 v[184:187], v252, s[52:55], s89 offen nt
buffer_load_dwordx4 v[188:191], v252, s[52:55], s90 offen nt
buffer_load_dwordx4 v[192:195], v252, s[52:55], s91 offen nt
buffer_load_dwordx4 v[196:199], v252, s[52:55], s92 offen nt
s_mov_b32 s48, s26
s_mov_b32 s49, s27
s_mov_b32 s50, 1211008
s_mov_b32 s51, 0x20000
s_mov_b32 s40, s12
s_mov_b32 s41, s13
s_mov_b32 s42, 5242880
s_mov_b32 s43, 0x20000
s_mov_b32 s80, 0x40000
v_and_b32 v14, 1, v0
v_lshlrev_b32 v14, 4, v14
v_mov_b32 v15, 0xffff
v_lshlrev_b32 v14, v14, v15
v_and_b32 v15, 7, v0
v_lshrrev_b32 v15, 1, v15
v_cmp_eq_u32 vcc, 0, v15
s_nop 1
v_cndmask_b32 v4, 0, v14, vcc
v_cmp_eq_u32 vcc, 1, v15
s_nop 1
v_cndmask_b32 v5, 0, v14, vcc
v_cmp_eq_u32 vcc, 2, v15
s_nop 1
v_cndmask_b32 v6, 0, v14, vcc
v_cmp_eq_u32 vcc, 3, v15
s_nop 1
v_cndmask_b32 v7, 0, v14, vcc
v_and_b32 v14, 4, v0
v_cmp_eq_u32 vcc, 0, v14
v_mov_b32 v14, 0xffff
s_nop 0
v_cndmask_b32 v8, 0, v14, vcc
v_cndmask_b32 v9, v14, 0, vcc
v_and_b32 v14, 3, v0
v_mul_u32_u24 v10, 0x5555, v14
s_mov_b32 s81, 0xffff0000
v_mov_b32 v246, 0x3acccccd
v_mov_b32 v249, 0xbdd2d3e8
v_lshrrev_b32 v14, 1, v13
s_mov_b32 s72, 52429
v_mul_lo_u32 v15, v14, s72
v_lshrrev_b32 v15, 19, v15
v_lshlrev_b32 v15, 1, v15
v_add_u32 v14, v14, v15
v_lshlrev_b32 v240, 2, v14
v_mul_u32_u24 v241, 48, v0
s_lshl_b32 s72, s3, 3
v_add_u32 v14, s72, v2
v_mul_u32_u24 v242, 48, v14
v_lshlrev_b32 v14, 2, v14
v_mul_u32_u24 v15, 544, v3
v_add_u32 v244, v14, v15
v_add_u32 v244, 3072, v244
v_lshrrev_b32 v14, 5, v0
v_bfe_u32 v15, v0, 3, 1
v_cmp_eq_u32 vcc, v14, v15
s_lshl_b32 s72, s3, 1
v_add_u32 v14, s72, v14
v_bfe_u32 v15, v0, 4, 1
v_lshlrev_b32 v15, 4, v15
v_lshl_add_u32 v15, v3, 5, v15
v_lshlrev_b32 v201, 4, v0
v_add_u32 v201, 42496, v201
v_mul_u32_u24 v202, 544, v14
v_add_u32 v202, v202, v15
v_add_u32 v202, 3072, v202
v_cndmask_b32 v243, v201, v202, vcc
v_mul_u32_u24 v202, 320, v14
v_add_u32 v202, v202, v15
v_add_u32 v202, 15872, v202
v_cndmask_b32 v245, v201, v202, vcc
s_waitcnt vmcnt(11)
v_lshlrev_b32 v204, 16, v228
v_and_b32 v205, s81, v228
v_lshlrev_b32 v216, 16, v236
v_and_b32 v217, s81, v236
v_lshlrev_b32 v206, 16, v229
v_and_b32 v207, s81, v229
v_lshlrev_b32 v218, 16, v237
v_and_b32 v219, s81, v237
v_lshlrev_b32 v208, 16, v230
v_and_b32 v209, s81, v230
v_lshlrev_b32 v220, 16, v238
v_and_b32 v221, s81, v238
v_lshlrev_b32 v210, 16, v231
v_and_b32 v211, s81, v231
v_lshlrev_b32 v222, 16, v239
v_and_b32 v223, s81, v239
v_lshlrev_b32 v212, 16, v232
v_and_b32 v213, s81, v232
v_lshlrev_b32 v224, 16, v233
v_and_b32 v225, s81, v233
v_bfe_u32 v14, v0, 2, 1
v_cmp_eq_u32 vcc, 1, v14
s_nop 1
v_cndmask_b32 v96, v216, v221, vcc
v_cndmask_b32 v97, v217, v222, vcc
v_cndmask_b32 v98, v218, v223, vcc
v_cndmask_b32 v99, v219, v224, vcc
v_cndmask_b32 v100, v220, v225, vcc
v_readfirstlane_b32 s72, v204
s_nop 1
v_mov_b32 v214, s72
v_pk_add_f32 v[204:205], v[204:205], v[214:215] op_sel_hi:[1,0] neg_lo:[0,1] neg_hi:[0,1]
v_pk_add_f32 v[206:207], v[206:207], v[214:215] op_sel_hi:[1,0] neg_lo:[0,1] neg_hi:[0,1]
v_pk_add_f32 v[208:209], v[208:209], v[214:215] op_sel_hi:[1,0] neg_lo:[0,1] neg_hi:[0,1]
v_pk_add_f32 v[210:211], v[210:211], v[214:215] op_sel_hi:[1,0] neg_lo:[0,1] neg_hi:[0,1]
v_pk_add_f32 v[212:213], v[212:213], v[214:215] op_sel_hi:[1,0] neg_lo:[0,1] neg_hi:[0,1]
v_pk_mul_f32 v[14:15], v[204:205], v[204:205]
v_pk_add_f32 v[204:205], v[204:205], v[206:207]
v_pk_fma_f32 v[14:15], v[206:207], v[206:207], v[14:15]
v_pk_add_f32 v[206:207], v[208:209], v[210:211]
v_pk_fma_f32 v[14:15], v[208:209], v[208:209], v[14:15]
v_pk_add_f32 v[204:205], v[204:205], v[212:213]
v_pk_fma_f32 v[14:15], v[210:211], v[210:211], v[14:15]
v_pk_add_f32 v[204:205], v[204:205], v[206:207]
v_pk_fma_f32 v[14:15], v[212:213], v[212:213], v[14:15]
v_add_f32 v204, v204, v205
v_add_f32 v14, v14, v15
s_nop 0
v_add_f32_dpp v204, v204, v204 row_ror:1 row_mask:0xf bank_mask:0xf
v_add_f32_dpp v14, v14, v14 row_ror:1 row_mask:0xf bank_mask:0xf
s_nop 0
v_add_f32_dpp v204, v204, v204 row_ror:2 row_mask:0xf bank_mask:0xf
v_add_f32_dpp v14, v14, v14 row_ror:2 row_mask:0xf bank_mask:0xf
s_nop 0
v_add_f32_dpp v204, v204, v204 row_ror:4 row_mask:0xf bank_mask:0xf
v_add_f32_dpp v14, v14, v14 row_ror:4 row_mask:0xf bank_mask:0xf
s_nop 0
v_add_f32_dpp v204, v204, v204 row_ror:8 row_mask:0xf bank_mask:0xf
v_add_f32_dpp v14, v14, v14 row_ror:8 row_mask:0xf bank_mask:0xf
s_nop 0
v_add_f32_dpp v204, v204, v204 row_bcast:15 row_mask:0xa bank_mask:0xf
v_add_f32_dpp v14, v14, v14 row_bcast:15 row_mask:0xa bank_mask:0xf
s_nop 0
v_add_f32_dpp v204, v204, v204 row_bcast:31 row_mask:0xc bank_mask:0xf
v_add_f32_dpp v14, v14, v14 row_bcast:31 row_mask:0xc bank_mask:0xf
v_readlane_b32 s72, v204, 63
v_readlane_b32 s73, v14, 63
s_nop 0
v_mul_f32 v14, s72, v246
v_mul_f32 v15, s73, v246
v_add_f32 v214, v214, v14
v_fma_f32 v15, -v14, v14, v15
v_cvt_pk_bf16_f32 v14, v214, v15
v_and_b32 v15, s81, v14
v_lshlrev_b32 v214, 16, v14
v_add_f32 v15, 0x3727c5ac, v15
v_cvt_pk_bf16_f32 v15, v15, v15
v_pk_add_f32 v[216:217], v[216:217], v[214:215] op_sel_hi:[1,0] neg_lo:[0,1] neg_hi:[0,1]
v_and_b32 v15, s81, v15
v_pk_add_f32 v[218:219], v[218:219], v[214:215] op_sel_hi:[1,0] neg_lo:[0,1] neg_hi:[0,1]
v_sqrt_f32 v15, v15
v_pk_add_f32 v[220:221], v[220:221], v[214:215] op_sel_hi:[1,0] neg_lo:[0,1] neg_hi:[0,1]
v_pk_add_f32 v[222:223], v[222:223], v[214:215] op_sel_hi:[1,0] neg_lo:[0,1] neg_hi:[0,1]
v_cvt_pk_bf16_f32 v15, v15, v15
v_pk_add_f32 v[224:225], v[224:225], v[214:215] op_sel_hi:[1,0] neg_lo:[0,1] neg_hi:[0,1]
v_and_b32 v15, s81, v15
v_cvt_pk_bf16_f32 v204, v216, v217
v_rcp_f32 v14, v15
v_cvt_pk_bf16_f32 v205, v218, v219
v_cvt_pk_bf16_f32 v206, v220, v221
v_cvt_pk_bf16_f32 v207, v222, v223
v_cvt_pk_bf16_f32 v208, v224, v225
v_lshlrev_b32 v216, 16, v204
v_and_b32 v217, s81, v204
v_lshlrev_b32 v218, 16, v205
v_and_b32 v219, s81, v205
v_lshlrev_b32 v220, 16, v206
v_and_b32 v221, s81, v206
v_lshlrev_b32 v222, 16, v207
v_and_b32 v223, s81, v207
v_lshlrev_b32 v224, 16, v208
v_and_b32 v225, s81, v208
v_pk_mul_f32 v[216:217], v[216:217], v[14:15] op_sel_hi:[1,0]
v_pk_mul_f32 v[218:219], v[218:219], v[14:15] op_sel_hi:[1,0]
v_pk_mul_f32 v[220:221], v[220:221], v[14:15] op_sel_hi:[1,0]
v_pk_mul_f32 v[222:223], v[222:223], v[14:15] op_sel_hi:[1,0]
v_pk_mul_f32 v[224:225], v[224:225], v[14:15] op_sel_hi:[1,0]
v_cvt_pk_bf16_f32 v216, v216, v216
v_cvt_pk_bf16_f32 v217, v217, v217
v_cvt_pk_bf16_f32 v218, v218, v218
v_cvt_pk_bf16_f32 v219, v219, v219
v_cvt_pk_bf16_f32 v220, v220, v220
v_cvt_pk_bf16_f32 v221, v221, v221
v_cvt_pk_bf16_f32 v222, v222, v222
v_cvt_pk_bf16_f32 v223, v223, v223
v_cvt_pk_bf16_f32 v224, v224, v224
v_cvt_pk_bf16_f32 v225, v225, v225
v_and_b32 v228, v216, v4
v_and_b32 v229, v216, v5
v_and_b32 v230, v216, v6
v_and_b32 v231, v216, v7
s_waitcnt vmcnt(9)
s_nop 0
v_mfma_f32_16x16x32_bf16 v[204:207], v[228:231], v[160:163], 0
v_and_b32 v232, v217, v4
v_and_b32 v233, v217, v5
v_and_b32 v234, v217, v6
v_and_b32 v235, v217, v7
s_waitcnt vmcnt(8)
s_nop 0
v_mfma_f32_16x16x32_bf16 v[204:207], v[232:235], v[164:167], v[204:207]
v_and_b32 v228, v218, v4
v_and_b32 v229, v218, v5
v_and_b32 v230, v218, v6
v_and_b32 v231, v218, v7
s_waitcnt vmcnt(7)
s_nop 0
v_mfma_f32_16x16x32_bf16 v[204:207], v[228:231], v[168:171], v[204:207]
v_and_b32 v232, v219, v4
v_and_b32 v233, v219, v5
v_and_b32 v234, v219, v6
v_and_b32 v235, v219, v7
s_waitcnt vmcnt(6)
s_nop 0
v_mfma_f32_16x16x32_bf16 v[204:207], v[232:235], v[172:175], v[204:207]
v_and_b32 v228, v220, v4
v_and_b32 v229, v220, v5
v_and_b32 v230, v220, v6
v_and_b32 v231, v220, v7
s_waitcnt vmcnt(5)
s_nop 0
v_mfma_f32_16x16x32_bf16 v[204:207], v[228:231], v[176:179], v[204:207]
v_and_b32 v232, v221, v4
v_and_b32 v233, v221, v5
v_and_b32 v234, v221, v6
v_and_b32 v235, v221, v7
s_waitcnt vmcnt(4)
s_nop 0
v_mfma_f32_16x16x32_bf16 v[204:207], v[232:235], v[180:183], v[204:207]
v_and_b32 v228, v222, v4
v_and_b32 v229, v222, v5
v_and_b32 v230, v222, v6
v_and_b32 v231, v222, v7
s_waitcnt vmcnt(3)
s_nop 0
v_mfma_f32_16x16x32_bf16 v[204:207], v[228:231], v[184:187], v[204:207]
v_and_b32 v232, v223, v4
v_and_b32 v233, v223, v5
v_and_b32 v234, v223, v6
v_and_b32 v235, v223, v7
s_waitcnt vmcnt(2)
s_nop 0
v_mfma_f32_16x16x32_bf16 v[204:207], v[232:235], v[188:191], v[204:207]
v_and_b32 v228, v224, v4
v_and_b32 v229, v224, v5
v_and_b32 v230, v224, v6
v_and_b32 v231, v224, v7
s_waitcnt vmcnt(1)
s_nop 0
v_mfma_f32_16x16x32_bf16 v[204:207], v[228:231], v[192:195], v[204:207]
v_and_b32 v232, v225, v4
v_and_b32 v233, v225, v5
v_and_b32 v234, v225, v6
v_and_b32 v235, v225, v7
s_waitcnt vmcnt(0)
s_nop 0
v_mfma_f32_16x16x32_bf16 v[204:207], v[232:235], v[196:199], v[204:207]
L_q_sum:
s_nop 7
ds_write_b128 v243, v[204:207]
s_waitcnt lgkmcnt(0)
s_or_b32 s93, s93, 0x01010101
s_add_u32 s93, s93, 1
s_or_b32 s93, s93, 0x01010101
s_and_b32 s56, s93, 0xff
s_bfe_u32 s57, s93, 0x80008
s_bfe_u32 s58, s93, 0x80010
s_lshr_b32 s59, s93, 24
v_and_b32 v14, 1, v0
v_cmp_eq_u32 vcc, 0, v14
v_mov_b32 v14, s56
v_mov_b32 v15, s57
v_mov_b32 v247, s58
v_mov_b32 v248, s59
v_cndmask_b32 v247, v247, v14, vcc
v_cndmask_b32 v248, v248, v15, vcc
s_barrier
s_cmp_lg_u32 s3, 0
s_cbranch_scc1 L_q_1
v_lshlrev_b32 v14, 2, v0
ds_read_b32 v204, v14 offset:3072
ds_read_b32 v205, v14 offset:3616
ds_read_b32 v206, v14 offset:4160
ds_read_b32 v207, v14 offset:4704
ds_read_b32 v208, v14 offset:5248
ds_read_b32 v209, v14 offset:5792
ds_read_b32 v210, v14 offset:6336
ds_read_b32 v211, v14 offset:6880
ds_read_b32 v212, v14 offset:7424
ds_read_b32 v213, v14 offset:7968
ds_read_b32 v214, v14 offset:8512
ds_read_b32 v215, v14 offset:9056
ds_read_b32 v216, v14 offset:9600
ds_read_b32 v217, v14 offset:10144
ds_read_b32 v218, v14 offset:10688
ds_read_b32 v219, v14 offset:11232
v_and_b32 v14, 15, v0
v_mul_u32_u24 v224, 24, v14
v_add_u32 v225, 8, v224
v_add_u32 v226, 16, v224
v_cmp_gt_u32 vcc, 11, v14
v_lshlrev_b32 v14, 4, v14
v_lshrrev_b32 v15, 4, v0
v_lshl_add_u32 v14, v15, 9, v14
s_lshr_b32 s72, s78, 1
s_mul_i32 s72, s72, 3072
s_and_b32 s73, s78, 1
s_lshl_b32 s73, s73, 8
s_add_u32 s72, s72, s73
v_mov_b32 v15, 2147483648
v_cndmask_b32 v14, v15, v14, vcc
v_cmp_gt_u32 vcc, 32, v0
s_nop 1
v_cndmask_b32 v15, v15, v14, vcc
v_mov_b32 v223, s93
s_waitcnt lgkmcnt(0)
v_pk_add_f32 v[204:205], v[204:205], v[212:213]
v_pk_add_f32 v[206:207], v[206:207], v[214:215]
v_pk_add_f32 v[208:209], v[208:209], v[216:217]
v_pk_add_f32 v[210:211], v[210:211], v[218:219]
v_pk_add_f32 v[204:205], v[204:205], v[208:209]
v_pk_add_f32 v[206:207], v[206:207], v[210:211]
v_pk_add_f32 v[204:205], v[204:205], v[206:207]
v_add_f32 v204, v204, v205
s_nop 1
v_mov_b32_dpp v205, v204 quad_perm:[1,0,3,2] row_mask:0xf bank_mask:0xf
v_cvt_pk_bf16_f32 v204, v204, v205
ds_bpermute_b32 v220, v224, v204
ds_bpermute_b32 v221, v225, v204
ds_bpermute_b32 v222, v226, v204
s_waitcnt lgkmcnt(0)
buffer_store_dwordx4 v[220:223], v14, s[48:51], s72 offen sc1
buffer_store_dwordx4 v[220:223], v15, s[48:51], s72 offen offset:2048 sc1
L_q_1:
s_barrier
s_sub_u32 s72, s2, 28
s_cmp_lt_u32 s72, 9
s_cbranch_scc1 L_go
s_cmp_lg_u32 s3, 0
s_cbranch_scc1 L_go1
s_lshl_b32 s72, s2, 7
s_add_u32 s72, s72, 167552
v_min_u32 v205, 11, v0
v_lshlrev_b32 v205, 2, v205
L_tr:
buffer_load_dword v204, v205, s[48:51], s72 offen sc1
s_waitcnt vmcnt(0)
v_cmp_eq_u32 vcc, s93, v204
s_cbranch_vccnz L_go1
s_sleep 4
s_sub_u32 s80, s80, 1
s_cbranch_scc0 L_tr
s_mov_b32 s80, 0
L_go1:
s_barrier
L_go:
s_cmp_ge_u32 s2, 37
s_cbranch_scc1 L_ld_f
buffer_load_dwordx4 v[96:99], v251, s[40:43], 0 offen offset:0 nt
buffer_load_dwordx4 v[104:107], v251, s[40:43], 0 offen offset:1280 nt
buffer_load_dwordx4 v[112:115], v251, s[40:43], 0 offen offset:2560 nt
buffer_load_dwordx4 v[120:123], v251, s[40:43], 0 offen offset:3840 nt
buffer_load_dwordx4 v[128:131], v251, s[40:43], s69 offen offset:0 nt
buffer_load_dwordx4 v[136:139], v251, s[40:43], s69 offen offset:1280 nt
buffer_load_dwordx4 v[144:147], v251, s[40:43], s69 offen offset:2560 nt
buffer_load_dwordx4 v[152:155], v251, s[40:43], s69 offen offset:3840 nt
buffer_load_dwordx4 v[100:103], v251, s[40:43], s70 offen offset:0 nt
buffer_load_dwordx4 v[108:111], v251, s[40:43], s70 offen offset:1280 nt
buffer_load_dwordx4 v[116:119], v251, s[40:43], s70 offen offset:2560 nt
buffer_load_dwordx4 v[124:127], v251, s[40:43], s70 offen offset:3840 nt
buffer_load_dwordx4 v[132:135], v251, s[40:43], s71 offen offset:0 nt
buffer_load_dwordx4 v[140:143], v251, s[40:43], s71 offen offset:1280 nt
buffer_load_dwordx4 v[148:151], v251, s[40:43], s71 offen offset:2560 nt
buffer_load_dwordx4 v[156:159], v251, s[40:43], s71 offen offset:3840 nt
s_cmp_lt_u32 s2, 28
s_cbranch_scc1 L_wo
s_mul_i32 s72, s79, 163840
s_mul_i32 s73, s3, 20480
s_add_u32 s72, s72, s73
s_lshl_b32 s73, s75, 7
s_add_u32 s72, s72, s73
v_mul_u32_u24 v14, 2560, v2
v_lshl_add_u32 v14, v3, 4, v14
v_add_u32 v14, s72, v14
s_mov_b32 s72, 163840
s_mov_b32 s73, 327680
buffer_load_dwordx4 v[16:19], v14, s[40:43], 0 offen offset:0 nt
buffer_load_dwordx4 v[20:23], v14, s[40:43], 0 offen offset:1280 nt
buffer_load_dwordx4 v[24:27], v14, s[40:43], s72 offen offset:0 nt
buffer_load_dwordx4 v[28:31], v14, s[40:43], s72 offen offset:1280 nt
buffer_load_dwordx4 v[32:35], v14, s[40:43], s73 offen offset:0 nt
buffer_load_dwordx4 v[36:39], v14, s[40:43], s73 offen offset:1280 nt
L_wo:
s_mul_i32 s83, s75, 6554
s_lshr_b32 s83, s83, 16
s_mul_i32 s83, s83, 122880
s_add_u32 s83, s83, 178176
s_mul_i32 s72, s76, 3840
s_add_u32 s72, s72, s83
v_lshlrev_b32 v202, 3, v0
v_add_u32 v203, s72, v202
v_and_b32 v14, 15, v0
v_cmp_gt_u32 vcc, 6, v14
s_nop 1
v_cndmask_b32 v205, 0, 1.0, vcc
v_min_u32 v14, 5, v14
v_mul_u32_u24 v14, 640, v14
v_add_u32 v204, s72, v14
s_lshl_b32 s72, s3, 9
s_add_u32 s72, s72, 11776
v_add_u32 v202, s72, v202
v_lshlrev_b32 v206, 6, v2
v_add_u32 v206, s72, v206
v_lshrrev_b32 v14, 2, v0
v_and_b32 v15, 3, v0
v_lshlrev_b32 v14, 4, v14
v_cmp_gt_u32 vcc, 1, v15
v_mul_u32_u24 v208, 10240, v15
v_mul_u32_u24 v15, 320, v15
v_add_u32 v207, v14, v15
v_add_u32 v14, v14, v208
s_mul_i32 s72, s74, 2560
s_lshl_b32 s73, s75, 8
s_add_u32 s72, s72, s73
s_add_u32 s72, s72, 1161216
v_add_u32 v14, s72, v14
v_mov_b32 v15, 2147483648
v_cndmask_b32 v208, v15, v14, vcc
v_bfe_u32 v14, v0, 4, 1
v_bfe_u32 v15, v0, 3, 1
v_lshl_add_u32 v14, v14, 2, v15
v_lshrrev_b32 v15, 5, v0
v_lshl_add_u32 v209, v14, 1, v15
s_lshl_b32 s72, s3, 9
s_add_u32 s72, s72, 11776
v_lshl_add_u32 v206, v209, 5, s72
v_mov_b32 v252, 0
v_mov_b32 v253, 0
v_mov_b32 v254, 0
v_mov_b32 v255, 0
s_cmp_ge_u32 s2, 28
s_cbranch_scc0 L_wo4
v_lshrrev_b32 v14, 4, v0
v_min_u32 v14, 2, v14
v_add_u32 v14, s79, v14
v_min_u32 v14, 31, v14
v_mul_u32_u24 v14, 3840, v14
v_add_u32 v14, s83, v14
v_and_b32 v15, 15, v0
v_lshl_add_u32 v52, v15, 2, v14
s_lshl_b32 s72, s3, 6
v_add_u32 v52, s72, v52
v_min_u32 v15, 5, v15
v_mul_u32_u24 v15, 640, v15
v_add_u32 v53, v14, v15
v_and_b32 v14, 3, v0
v_lshlrev_b32 v14, 3, v14
v_lshrrev_b32 v54, v14, s93
v_and_b32 v54, 0xff, v54
s_lshl_b32 s72, s3, 8
s_add_u32 s72, s72, 20992
v_lshl_add_u32 v55, v0, 2, s72
v_lshl_add_u32 v56, v209, 2, s72
s_cmp_lg_u32 s74, 0
s_cbranch_scc1 L_noz
s_cmp_lg_u32 s3, 0
s_cbranch_scc1 L_noz
v_mov_b32 v212, s56
v_mov_b32 v213, s57
v_mov_b32 v214, s58
v_mov_b32 v215, s59
s_mov_b32 s72, 7680
buffer_store_dwordx4 v[212:215], v208, s[48:51], s72 offen sc1
L_noz:
L_h1ax:
buffer_load_dword v210, v204, s[48:51], 0 offen offset:520 sc1
s_waitcnt vmcnt(0)
v_cmp_eq_u32 vcc, s93, v210
s_and_b32 s72, vcc_lo, 63
s_bcnt1_i32_b32 s72, s72
s_cmp_ge_u32 s72, 1
s_cbranch_scc1 L_h1x
s_sub_u32 s80, s80, 1
s_cbranch_scc0 L_h1ax
s_mov_b32 s80, 0
L_h1x:
buffer_load_dwordx3 v[172:174], v204, s[48:51], 0 offen offset:512 sc1
buffer_load_dwordx3 v[46:48], v53, s[48:51], 0 offen offset:512 sc1
buffer_load_dwordx2 v[160:161], v203, s[48:51], 0 offen offset:0 sc1
buffer_load_dwordx2 v[162:163], v203, s[48:51], 0 offen offset:640 sc1
buffer_load_dwordx2 v[164:165], v203, s[48:51], 0 offen offset:1280 sc1
buffer_load_dwordx2 v[166:167], v203, s[48:51], 0 offen offset:1920 sc1
buffer_load_dwordx2 v[168:169], v203, s[48:51], 0 offen offset:2560 sc1
buffer_load_dwordx2 v[170:171], v203, s[48:51], 0 offen offset:3200 sc1
buffer_load_dword v40, v52, s[48:51], 0 offen offset:0 sc1
buffer_load_dword v41, v52, s[48:51], 0 offen offset:640 sc1
buffer_load_dword v42, v52, s[48:51], 0 offen offset:1280 sc1
buffer_load_dword v43, v52, s[48:51], 0 offen offset:1920 sc1
buffer_load_dword v44, v52, s[48:51], 0 offen offset:2560 sc1
buffer_load_dword v45, v52, s[48:51], 0 offen offset:3200 sc1
s_mov_b32 s64, 0
v_mov_b32 v252, 0
v_mov_b32 v253, 0
v_mov_b32 v254, 0
v_mov_b32 v255, 0
v_mov_b32 v80, 0
v_mov_b32 v81, 0
v_mov_b32 v82, 0
v_mov_b32 v83, 0
s_waitcnt vmcnt(0)
L_h1sx:
v_xor_b32 v76, s93, v174
v_xor_b32 v77, s93, v48
v_msad_u8 v64, v160, v247, 0
v_msad_u8 v65, v162, v247, 0
v_msad_u8 v66, v164, v247, 0
v_msad_u8 v67, v166, v247, 0
v_msad_u8 v68, v168, v247, 0
v_msad_u8 v69, v170, v247, 0
v_msad_u8 v70, v40, v54, 0
v_msad_u8 v71, v41, v54, 0
v_msad_u8 v72, v42, v54, 0
v_msad_u8 v73, v43, v54, 0
v_msad_u8 v74, v44, v54, 0
v_msad_u8 v75, v45, v54, 0
v_msad_u8 v64, v161, v248, v64
v_msad_u8 v65, v163, v248, v65
v_msad_u8 v66, v165, v248, v66
v_msad_u8 v67, v167, v248, v67
v_msad_u8 v68, v169, v248, v68
v_msad_u8 v69, v171, v248, v69
v_or3_b32 v14, v76, v64, v65
v_or3_b32 v15, v77, v70, v71
v_or3_b32 v14, v14, v66, v67
v_or3_b32 v15, v15, v72, v73
v_or3_b32 v14, v14, v68, v69
v_or3_b32 v15, v15, v74, v75
v_cmp_ne_u32 s[60:61], 0, v14
v_cmp_ne_u32 s[62:63], 0, v15
s_or_b64 vcc, s[60:61], s[62:63]
s_cbranch_scc0 L_x2p
v_cmp_ne_u32 vcc, 0, v76
s_cbranch_vccz L_h1kx0
buffer_load_dwordx3 v[172:174], v204, s[48:51], 0 offen offset:512 sc1
L_h1kx0:
v_cmp_ne_u32 vcc, 0, v77
s_cbranch_vccz L_h1kx1
buffer_load_dwordx3 v[46:48], v53, s[48:51], 0 offen offset:512 sc1
L_h1kx1:
v_cmp_ne_u32 vcc, 0, v64
s_cbranch_vccz L_h1kx2
buffer_load_dwordx2 v[160:161], v203, s[48:51], 0 offen offset:0 sc1
L_h1kx2:
v_cmp_ne_u32 vcc, 0, v65
s_cbranch_vccz L_h1kx3
buffer_load_dwordx2 v[162:163], v203, s[48:51], 0 offen offset:640 sc1
L_h1kx3:
v_cmp_ne_u32 vcc, 0, v66
s_cbranch_vccz L_h1kx4
buffer_load_dwordx2 v[164:165], v203, s[48:51], 0 offen offset:1280 sc1
L_h1kx4:
v_cmp_ne_u32 vcc, 0, v67
s_cbranch_vccz L_h1kx5
buffer_load_dwordx2 v[166:167], v203, s[48:51], 0 offen offset:1920 sc1
L_h1kx5:
v_cmp_ne_u32 vcc, 0, v68
s_cbranch_vccz L_h1kx6
buffer_load_dwordx2 v[168:169], v203, s[48:51], 0 offen offset:2560 sc1
L_h1kx6:
v_cmp_ne_u32 vcc, 0, v69
s_cbranch_vccz L_h1kx7
buffer_load_dwordx2 v[170:171], v203, s[48:51], 0 offen offset:3200 sc1
L_h1kx7:
v_cmp_ne_u32 vcc, 0, v70
s_cbranch_vccz L_h1kx8
buffer_load_dword v40, v52, s[48:51], 0 offen offset:0 sc1
L_h1kx8:
v_cmp_ne_u32 vcc, 0, v71
s_cbranch_vccz L_h1kx9
buffer_load_dword v41, v52, s[48:51], 0 offen offset:640 sc1
L_h1kx9:
v_cmp_ne_u32 vcc, 0, v72
s_cbranch_vccz L_h1kx10
buffer_load_dword v42, v52, s[48:51], 0 offen offset:1280 sc1
L_h1kx10:
v_cmp_ne_u32 vcc, 0, v73
s_cbranch_vccz L_h1kx11
buffer_load_dword v43, v52, s[48:51], 0 offen offset:1920 sc1
L_h1kx11:
v_cmp_ne_u32 vcc, 0, v74
s_cbranch_vccz L_h1kx12
buffer_load_dword v44, v52, s[48:51], 0 offen offset:2560 sc1
L_h1kx12:
v_cmp_ne_u32 vcc, 0, v75
s_cbranch_vccz L_h1kx13
buffer_load_dword v45, v52, s[48:51], 0 offen offset:3200 sc1
L_h1kx13:
s_sub_u32 s80, s80, 1
s_cbranch_scc0 L_x2p
s_mov_b32 s80, 0
s_waitcnt vmcnt(0)
s_mov_b64 s[60:61], 0
s_mov_b64 s[62:63], 0
L_x2p:
s_bitcmp1_b32 s64, 0
s_cbranch_scc1 L_x2m
s_cmp_lg_u64 s[60:61], 0
s_cbranch_scc1 L_x2m
s_or_b32 s64, s64, 1
v_mov_b32 v247, 0
v_mov_b32 v248, 0
v_max_f32_dpp v14, v172, v172 quad_perm:[1,0,3,2] row_mask:0xf bank_mask:0xf
v_and_b32 v160, 0xffffff00, v160
v_and_b32 v161, 0xffffff00, v161
v_mul_f32 v15, v173, v205
v_and_b32 v162, 0xffffff00, v162
v_and_b32 v163, 0xffffff00, v163
v_max_f32_dpp v14, v14, v14 quad_perm:[2,3,0,1] row_mask:0xf bank_mask:0xf
v_and_b32 v164, 0xffffff00, v164
v_and_b32 v165, 0xffffff00, v165
v_max_f32_dpp v14, v14, v14 row_half_mirror row_mask:0xf bank_mask:0xf
v_and_b32 v166, 0xffffff00, v166
v_and_b32 v167, 0xffffff00, v167
v_sub_f32 v14, v172, v14
v_and_b32 v168, 0xffffff00, v168
v_and_b32 v169, 0xffffff00, v169
v_exp_f32 v14, v14
v_and_b32 v170, 0xffffff00, v170
v_and_b32 v171, 0xffffff00, v171
v_mul_f32 v15, v14, v15
v_mul_f32_dpp v224, v14, v160 row_newbcast:0 row_mask:0xf bank_mask:0xf
v_mul_f32_dpp v225, v14, v161 row_newbcast:0 row_mask:0xf bank_mask:0xf
v_add_f32_dpp v15, v15, v15 quad_perm:[1,0,3,2] row_mask:0xf bank_mask:0xf
v_fmac_f32_dpp v224, v14, v162 row_newbcast:1 row_mask:0xf bank_mask:0xf
v_fmac_f32_dpp v225, v14, v163 row_newbcast:1 row_mask:0xf bank_mask:0xf
v_add_f32_dpp v15, v15, v15 quad_perm:[2,3,0,1] row_mask:0xf bank_mask:0xf
v_fmac_f32_dpp v224, v14, v164 row_newbcast:2 row_mask:0xf bank_mask:0xf
v_fmac_f32_dpp v225, v14, v165 row_newbcast:2 row_mask:0xf bank_mask:0xf
v_add_f32_dpp v15, v15, v15 row_half_mirror row_mask:0xf bank_mask:0xf
v_fmac_f32_dpp v224, v14, v166 row_newbcast:3 row_mask:0xf bank_mask:0xf
v_fmac_f32_dpp v225, v14, v167 row_newbcast:3 row_mask:0xf bank_mask:0xf
v_rcp_f32 v15, v15
v_fmac_f32_dpp v224, v14, v168 row_newbcast:4 row_mask:0xf bank_mask:0xf
v_fmac_f32_dpp v225, v14, v169 row_newbcast:4 row_mask:0xf bank_mask:0xf
s_nop 0
v_fmac_f32_dpp v224, v14, v170 row_newbcast:5 row_mask:0xf bank_mask:0xf
v_fmac_f32_dpp v225, v14, v171 row_newbcast:5 row_mask:0xf bank_mask:0xf
s_nop 0
v_mul_f32_dpp v224, v15, v224 row_newbcast:0 row_mask:0xf bank_mask:0xf
v_mul_f32_dpp v225, v15, v225 row_newbcast:0 row_mask:0xf bank_mask:0xf
v_cvt_pk_bf16_f32 v224, v224, v224
v_cvt_pk_bf16_f32 v225, v225, v225
ds_write_b64 v202, v[224:225]
ds_read_b128 v[212:215], v206 offset:0
ds_read_b128 v[220:223], v206 offset:128
ds_read_b128 v[216:219], v206 offset:16
ds_read_b128 v[224:227], v206 offset:144
s_waitcnt lgkmcnt(2)
v_and_b32 v228, v212, v8
v_and_b32 v229, v212, v9
v_and_b32 v230, v220, v8
v_and_b32 v231, v220, v9
v_and_b32 v232, v213, v8
v_and_b32 v233, v213, v9
v_and_b32 v234, v221, v8
v_and_b32 v235, v221, v9
v_smfmac_f32_16x16x64_bf16 v[252:255], v[228:231], v[96:103], v10
v_and_b32 v236, v214, v8
v_and_b32 v237, v214, v9
v_and_b32 v238, v222, v8
v_and_b32 v239, v222, v9
v_smfmac_f32_16x16x64_bf16 v[252:255], v[232:235], v[104:111], v10
v_and_b32 v228, v215, v8
v_and_b32 v229, v215, v9
v_and_b32 v230, v223, v8
v_and_b32 v231, v223, v9
v_smfmac_f32_16x16x64_bf16 v[252:255], v[236:239], v[112:119], v10
s_waitcnt lgkmcnt(0)
v_and_b32 v232, v216, v8
v_and_b32 v233, v216, v9
v_and_b32 v234, v224, v8
v_and_b32 v235, v224, v9
v_smfmac_f32_16x16x64_bf16 v[252:255], v[228:231], v[120:127], v10
v_and_b32 v236, v217, v8
v_and_b32 v237, v217, v9
v_and_b32 v238, v225, v8
v_and_b32 v239, v225, v9
v_smfmac_f32_16x16x64_bf16 v[252:255], v[232:235], v[128:135], v10
v_and_b32 v228, v218, v8
v_and_b32 v229, v218, v9
v_and_b32 v230, v226, v8
v_and_b32 v231, v226, v9
v_smfmac_f32_16x16x64_bf16 v[252:255], v[236:239], v[136:143], v10
v_and_b32 v232, v219, v8
v_and_b32 v233, v219, v9
v_and_b32 v234, v227, v8
v_and_b32 v235, v227, v9
v_smfmac_f32_16x16x64_bf16 v[252:255], v[228:231], v[144:151], v10
s_nop 0
v_smfmac_f32_16x16x64_bf16 v[252:255], v[232:235], v[152:159], v10
L_x2m:
s_bitcmp1_b32 s64, 1
s_cbranch_scc1 L_x2e
s_cmp_lg_u64 s[62:63], 0
s_cbranch_scc1 L_x2e
s_or_b32 s64, s64, 2
v_mov_b32 v54, 0
v_max_f32_dpp v50, v46, v46 quad_perm:[1,0,3,2] row_mask:0xf bank_mask:0xf
v_and_b32 v40, 0xffffff00, v40
v_mul_f32 v51, v47, v205
v_and_b32 v41, 0xffffff00, v41
v_max_f32_dpp v50, v50, v50 quad_perm:[2,3,0,1] row_mask:0xf bank_mask:0xf
v_and_b32 v42, 0xffffff00, v42
s_nop 0
v_max_f32_dpp v50, v50, v50 row_half_mirror row_mask:0xf bank_mask:0xf
v_and_b32 v43, 0xffffff00, v43
v_sub_f32 v50, v46, v50
v_and_b32 v44, 0xffffff00, v44
v_exp_f32 v50, v50
v_and_b32 v45, 0xffffff00, v45
v_mul_f32 v51, v50, v51
v_mul_f32_dpp v49, v50, v40 row_newbcast:0 row_mask:0xf bank_mask:0xf
s_nop 0
v_add_f32_dpp v51, v51, v51 quad_perm:[1,0,3,2] row_mask:0xf bank_mask:0xf
v_fmac_f32_dpp v49, v50, v41 row_newbcast:1 row_mask:0xf bank_mask:0xf
s_nop 0
v_add_f32_dpp v51, v51, v51 quad_perm:[2,3,0,1] row_mask:0xf bank_mask:0xf
v_fmac_f32_dpp v49, v50, v42 row_newbcast:2 row_mask:0xf bank_mask:0xf
s_nop 0
v_add_f32_dpp v51, v51, v51 row_half_mirror row_mask:0xf bank_mask:0xf
v_fmac_f32_dpp v49, v50, v43 row_newbcast:3 row_mask:0xf bank_mask:0xf
v_rcp_f32 v51, v51
s_nop 0
v_fmac_f32_dpp v49, v50, v44 row_newbcast:4 row_mask:0xf bank_mask:0xf
s_nop 1
v_fmac_f32_dpp v49, v50, v45 row_newbcast:5 row_mask:0xf bank_mask:0xf
s_nop 1
v_mul_f32_dpp v49, v51, v49 row_newbcast:0 row_mask:0xf bank_mask:0xf
v_cvt_pk_bf16_f32 v49, v49, v49
ds_write_b32 v55, v49
ds_read2_b32 v[58:59], v56 offset0:0 offset1:4
ds_read2_b32 v[60:61], v56 offset0:16 offset1:20
ds_read2_b32 v[62:63], v56 offset0:32 offset1:36
s_waitcnt lgkmcnt(2)
v_and_b32 v228, v58, v8
v_and_b32 v229, v58, v9
v_and_b32 v230, v59, v8
v_and_b32 v231, v59, v9
s_waitcnt lgkmcnt(1)
v_and_b32 v232, v60, v8
v_and_b32 v233, v60, v9
v_and_b32 v234, v61, v8
v_and_b32 v235, v61, v9
v_smfmac_f32_16x16x64_bf16 v[80:83], v[228:231], v[16:23], v10
s_waitcnt lgkmcnt(0)
v_and_b32 v236, v62, v8
v_and_b32 v237, v62, v9
v_and_b32 v238, v63, v8
v_and_b32 v239, v63, v9
v_smfmac_f32_16x16x64_bf16 v[80:83], v[232:235], v[24:31], v10
s_nop 0
v_smfmac_f32_16x16x64_bf16 v[80:83], v[236:239], v[32:39], v10
L_x2e:
s_waitcnt vmcnt(0)
s_cmp_lg_u32 s64, 3
s_cbranch_scc1 L_h1sx
s_nop 4
v_pk_add_f32 v[252:253], v[252:253], v[80:81]
v_pk_add_f32 v[254:255], v[254:255], v[82:83]
s_branch L_wo_acc
L_wo4:
L_h1a:
buffer_load_dword v210, v204, s[48:51], 0 offen offset:520 sc1
s_waitcnt vmcnt(0)
v_cmp_eq_u32 vcc, s93, v210
s_and_b32 s72, vcc_lo, 63
s_bcnt1_i32_b32 s72, s72
s_cmp_ge_u32 s72, 1
s_cbranch_scc1 L_h1
s_sub_u32 s80, s80, 1
s_cbranch_scc0 L_h1a
s_mov_b32 s80, 0
L_h1:
buffer_load_dwordx3 v[172:174], v204, s[48:51], 0 offen offset:512 sc1
buffer_load_dwordx2 v[160:161], v203, s[48:51], 0 offen offset:0 sc1
buffer_load_dwordx2 v[162:163], v203, s[48:51], 0 offen offset:640 sc1
buffer_load_dwordx2 v[164:165], v203, s[48:51], 0 offen offset:1280 sc1
buffer_load_dwordx2 v[166:167], v203, s[48:51], 0 offen offset:1920 sc1
buffer_load_dwordx2 v[168:169], v203, s[48:51], 0 offen offset:2560 sc1
buffer_load_dwordx2 v[170:171], v203, s[48:51], 0 offen offset:3200 sc1
s_waitcnt vmcnt(0)
L_h1s:
v_xor_b32 v76, s93, v174
v_msad_u8 v64, v160, v247, 0
v_msad_u8 v65, v162, v247, 0
v_msad_u8 v66, v164, v247, 0
v_msad_u8 v67, v166, v247, 0
v_msad_u8 v68, v168, v247, 0
v_msad_u8 v69, v170, v247, 0
v_msad_u8 v64, v161, v248, v64
v_msad_u8 v65, v163, v248, v65
v_msad_u8 v66, v165, v248, v66
v_msad_u8 v67, v167, v248, v67
v_msad_u8 v68, v169, v248, v68
v_msad_u8 v69, v171, v248, v69
v_or3_b32 v14, v76, v64, v65
v_or3_b32 v15, v66, v67, v68
v_or3_b32 v14, v14, v15, v69
v_cmp_ne_u32 vcc, 0, v14
s_cbranch_vccz L_h1ok
v_cmp_ne_u32 vcc, 0, v76
s_cbranch_vccz L_h1k0
buffer_load_dwordx3 v[172:174], v204, s[48:51], 0 offen offset:512 sc1
L_h1k0:
v_cmp_ne_u32 vcc, 0, v64
s_cbranch_vccz L_h1k1
buffer_load_dwordx2 v[160:161], v203, s[48:51], 0 offen offset:0 sc1
L_h1k1:
v_cmp_ne_u32 vcc, 0, v65
s_cbranch_vccz L_h1k2
buffer_load_dwordx2 v[162:163], v203, s[48:51], 0 offen offset:640 sc1
L_h1k2:
v_cmp_ne_u32 vcc, 0, v66
s_cbranch_vccz L_h1k3
buffer_load_dwordx2 v[164:165], v203, s[48:51], 0 offen offset:1280 sc1
L_h1k3:
v_cmp_ne_u32 vcc, 0, v67
s_cbranch_vccz L_h1k4
buffer_load_dwordx2 v[166:167], v203, s[48:51], 0 offen offset:1920 sc1
L_h1k4:
v_cmp_ne_u32 vcc, 0, v68
s_cbranch_vccz L_h1k5
buffer_load_dwordx2 v[168:169], v203, s[48:51], 0 offen offset:2560 sc1
L_h1k5:
v_cmp_ne_u32 vcc, 0, v69
s_cbranch_vccz L_h1k6
buffer_load_dwordx2 v[170:171], v203, s[48:51], 0 offen offset:3200 sc1
L_h1k6:
s_waitcnt vmcnt(0)
s_sub_u32 s80, s80, 1
s_cbranch_scc0 L_h1s
s_mov_b32 s80, 0
L_h1ok:
v_max_f32_dpp v14, v172, v172 quad_perm:[1,0,3,2] row_mask:0xf bank_mask:0xf
v_and_b32 v160, 0xffffff00, v160
v_and_b32 v161, 0xffffff00, v161
v_mul_f32 v15, v173, v205
v_and_b32 v162, 0xffffff00, v162
v_and_b32 v163, 0xffffff00, v163
v_max_f32_dpp v14, v14, v14 quad_perm:[2,3,0,1] row_mask:0xf bank_mask:0xf
v_and_b32 v164, 0xffffff00, v164
v_and_b32 v165, 0xffffff00, v165
v_max_f32_dpp v14, v14, v14 row_half_mirror row_mask:0xf bank_mask:0xf
v_and_b32 v166, 0xffffff00, v166
v_and_b32 v167, 0xffffff00, v167
v_sub_f32 v14, v172, v14
v_and_b32 v168, 0xffffff00, v168
v_and_b32 v169, 0xffffff00, v169
v_exp_f32 v14, v14
v_and_b32 v170, 0xffffff00, v170
v_and_b32 v171, 0xffffff00, v171
v_mul_f32 v15, v14, v15
v_mul_f32_dpp v224, v14, v160 row_newbcast:0 row_mask:0xf bank_mask:0xf
v_mul_f32_dpp v225, v14, v161 row_newbcast:0 row_mask:0xf bank_mask:0xf
v_add_f32_dpp v15, v15, v15 quad_perm:[1,0,3,2] row_mask:0xf bank_mask:0xf
v_fmac_f32_dpp v224, v14, v162 row_newbcast:1 row_mask:0xf bank_mask:0xf
v_fmac_f32_dpp v225, v14, v163 row_newbcast:1 row_mask:0xf bank_mask:0xf
v_add_f32_dpp v15, v15, v15 quad_perm:[2,3,0,1] row_mask:0xf bank_mask:0xf
v_fmac_f32_dpp v224, v14, v164 row_newbcast:2 row_mask:0xf bank_mask:0xf
v_fmac_f32_dpp v225, v14, v165 row_newbcast:2 row_mask:0xf bank_mask:0xf
v_add_f32_dpp v15, v15, v15 row_half_mirror row_mask:0xf bank_mask:0xf
v_fmac_f32_dpp v224, v14, v166 row_newbcast:3 row_mask:0xf bank_mask:0xf
v_fmac_f32_dpp v225, v14, v167 row_newbcast:3 row_mask:0xf bank_mask:0xf
v_rcp_f32 v15, v15
v_fmac_f32_dpp v224, v14, v168 row_newbcast:4 row_mask:0xf bank_mask:0xf
v_fmac_f32_dpp v225, v14, v169 row_newbcast:4 row_mask:0xf bank_mask:0xf
s_nop 0
v_fmac_f32_dpp v224, v14, v170 row_newbcast:5 row_mask:0xf bank_mask:0xf
v_fmac_f32_dpp v225, v14, v171 row_newbcast:5 row_mask:0xf bank_mask:0xf
s_nop 0
v_mul_f32_dpp v224, v15, v224 row_newbcast:0 row_mask:0xf bank_mask:0xf
v_mul_f32_dpp v225, v15, v225 row_newbcast:0 row_mask:0xf bank_mask:0xf
v_cvt_pk_bf16_f32 v224, v224, v224
v_cvt_pk_bf16_f32 v225, v225, v225
ds_write_b64 v202, v[224:225]
ds_read_b128 v[212:215], v206 offset:0
ds_read_b128 v[220:223], v206 offset:128
ds_read_b128 v[216:219], v206 offset:16
ds_read_b128 v[224:227], v206 offset:144
s_waitcnt lgkmcnt(2)
v_and_b32 v228, v212, v8
v_and_b32 v229, v212, v9
v_and_b32 v230, v220, v8
v_and_b32 v231, v220, v9
v_and_b32 v232, v213, v8
v_and_b32 v233, v213, v9
v_and_b32 v234, v221, v8
v_and_b32 v235, v221, v9
v_smfmac_f32_16x16x64_bf16 v[252:255], v[228:231], v[96:103], v10
v_and_b32 v236, v214, v8
v_and_b32 v237, v214, v9
v_and_b32 v238, v222, v8
v_and_b32 v239, v222, v9
v_smfmac_f32_16x16x64_bf16 v[252:255], v[232:235], v[104:111], v10
v_and_b32 v228, v215, v8
v_and_b32 v229, v215, v9
v_and_b32 v230, v223, v8
v_and_b32 v231, v223, v9
v_smfmac_f32_16x16x64_bf16 v[252:255], v[236:239], v[112:119], v10
s_waitcnt lgkmcnt(0)
v_and_b32 v232, v216, v8
v_and_b32 v233, v216, v9
v_and_b32 v234, v224, v8
v_and_b32 v235, v224, v9
v_smfmac_f32_16x16x64_bf16 v[252:255], v[228:231], v[120:127], v10
v_and_b32 v236, v217, v8
v_and_b32 v237, v217, v9
v_and_b32 v238, v225, v8
v_and_b32 v239, v225, v9
v_smfmac_f32_16x16x64_bf16 v[252:255], v[232:235], v[128:135], v10
v_and_b32 v228, v218, v8
v_and_b32 v229, v218, v9
v_and_b32 v230, v226, v8
v_and_b32 v231, v226, v9
v_smfmac_f32_16x16x64_bf16 v[252:255], v[236:239], v[136:143], v10
v_and_b32 v232, v219, v8
v_and_b32 v233, v219, v9
v_and_b32 v234, v227, v8
v_and_b32 v235, v227, v9
v_smfmac_f32_16x16x64_bf16 v[252:255], v[228:231], v[144:151], v10
s_nop 0
v_smfmac_f32_16x16x64_bf16 v[252:255], v[232:235], v[152:159], v10
L_wo_acc:
s_nop 7
ds_write_b128 v245, v[252:255]
s_waitcnt lgkmcnt(0)
s_barrier
s_cmp_lg_u32 s3, 0
s_cbranch_scc1 L_wo_done
ds_read_b128 v[212:215], v207 offset:15872
ds_read_b128 v[216:219], v207 offset:17152
ds_read_b128 v[220:223], v207 offset:18432
ds_read_b128 v[224:227], v207 offset:19712
v_mov_b32 v14, 0xff
s_waitcnt lgkmcnt(2)
v_pk_add_f32 v[212:213], v[212:213], v[216:217]
v_pk_add_f32 v[214:215], v[214:215], v[218:219]
s_waitcnt lgkmcnt(0)
v_pk_add_f32 v[220:221], v[220:221], v[224:225]
v_pk_add_f32 v[222:223], v[222:223], v[226:227]
v_pk_add_f32 v[212:213], v[212:213], v[220:221]
v_pk_add_f32 v[214:215], v[214:215], v[222:223]
s_nop 0
v_add_f32_dpp v212, v212, v212 quad_perm:[1,0,3,2] row_mask:0xf bank_mask:0xf
v_add_f32_dpp v213, v213, v213 quad_perm:[1,0,3,2] row_mask:0xf bank_mask:0xf
v_add_f32_dpp v214, v214, v214 quad_perm:[1,0,3,2] row_mask:0xf bank_mask:0xf
v_add_f32_dpp v215, v215, v215 quad_perm:[1,0,3,2] row_mask:0xf bank_mask:0xf
v_add_f32_dpp v212, v212, v212 quad_perm:[2,3,0,1] row_mask:0xf bank_mask:0xf
v_add_f32_dpp v213, v213, v213 quad_perm:[2,3,0,1] row_mask:0xf bank_mask:0xf
v_add_f32_dpp v214, v214, v214 quad_perm:[2,3,0,1] row_mask:0xf bank_mask:0xf
v_add_f32_dpp v215, v215, v215 quad_perm:[2,3,0,1] row_mask:0xf bank_mask:0xf
v_bfi_b32 v212, v14, s56, v212
v_bfi_b32 v213, v14, s57, v213
v_bfi_b32 v214, v14, s58, v214
v_bfi_b32 v215, v14, s59, v215
buffer_store_dwordx4 v[212:215], v208, s[48:51], 0 offen sc1
L_wo_done:
s_cmp_ge_u32 s2, 20
s_cbranch_scc1 L_aux_end
s_cmp_lg_u32 s3, 7
s_cbranch_scc1 L_aux_end
s_mov_b32 s52, s22
s_mov_b32 s53, s23
s_mov_b32 s54, 1280
s_mov_b32 s55, 0x20000
s_lshl_b32 s72, s2, 7
v_mul_u32_u24 v14, 2560, v2
v_lshl_add_u32 v14, v3, 4, v14
v_add_u32 v14, s72, v14
s_and_b32 s73, s2, 0
s_mul_i32 s73, s73, 10240
s_add_u32 s73, s73, 1161216
v_add_u32 v202, s73, v14
v_mov_b32 v15, 2147483648
v_cmp_gt_u32 vcc, 32, v0
s_nop 1
v_cndmask_b32 v202, v15, v202, vcc
v_add_u32 v203, 98432, v14
v_add_u32 v204, 159872, v14
v_cmp_gt_u32 vcc, 24, v0
s_nop 1
v_cndmask_b32 v204, v15, v204, vcc
v_bfe_u32 v14, v0, 4, 1
v_lshrrev_b32 v205, 5, v0
v_lshl_add_u32 v14, v14, 1, v205
v_lshl_add_u32 v14, v3, 2, v14
v_lshlrev_b32 v14, 1, v14
s_lshl_b32 s72, s2, 6
v_add_u32 v14, s72, v14
buffer_load_ushort v206, v14, s[28:31], 0 offen
v_bfe_u32 v205, v0, 3, 1
v_cmp_eq_u32 vcc, 0, v205
s_nop 1
v_cndmask_b32 v205, v15, v14, vcc
s_mov_b32 s72, 20480
s_mov_b32 s73, 40960
s_mov_b32 s60, 0xffffff
s_mov_b32 s61, 0
L_ry:
buffer_load_dwordx4 v[212:215], v202, s[48:51], 0 offen sc1
s_waitcnt vmcnt(0)
v_msad_u8 v14, v212, s56, 0
v_msad_u8 v15, v213, s57, 0
v_msad_u8 v14, v214, s58, v14
v_msad_u8 v15, v215, s59, v15
v_or_b32 v14, v14, v15
v_cmp_ne_u32 vcc, 0, v14
s_cmp_eq_u32 vcc_lo, 0
s_cbranch_scc1 L_ryok
s_sub_u32 s80, s80, 1
s_cbranch_scc0 L_ry
s_mov_b32 s80, 0
L_ryok:
s_cmp_lg_u32 s2, 0
s_cbranch_scc1 L_nocan
v_mov_b32 v14, s93
v_lshlrev_b32 v15, 2, v0
v_add_u32 v15, 98304, v15
s_mov_b32 exec_hi, 0
buffer_store_dword v14, v15, s[48:51], 0 offen sc1
s_mov_b64 exec, -1
L_nocan:
v_and_b32 v212, 0xffffff00, v212
v_and_b32 v213, 0xffffff00, v213
v_and_b32 v214, 0xffffff00, v214
v_and_b32 v215, 0xffffff00, v215
v_permlane32_swap_b32 v212, v213
s_nop 0
v_permlane32_swap_b32 v214, v215
v_add_f32 v212, v212, v213
v_add_f32 v214, v214, v215
s_nop 1
v_permlane16_swap_b32 v212, v214
v_add_f32 v212, v212, v214
s_nop 1
v_add_f32_dpp v212, v212, v212 row_ror:8 row_mask:0xf bank_mask:0xf
v_cvt_pk_bf16_f32 v212, v212, v212
v_lshlrev_b32 v206, 16, v206
v_and_b32 v212, s81, v212
v_add_f32 v212, v212, v206
v_cvt_pk_bf16_f32 v212, v212, v212
v_and_b32 v206, s81, v212
buffer_load_dwordx4 v[96:99], v203, s[48:51], 0 offen sc1
buffer_load_dwordx4 v[100:103], v203, s[48:51], s72 offen sc1
buffer_load_dwordx4 v[104:107], v203, s[48:51], s73 offen sc1
buffer_load_dwordx4 v[108:111], v204, s[48:51], 0 offen sc1
s_sleep 3
L_rd:
buffer_load_dwordx4 v[112:115], v203, s[48:51], 0 offen sc1
buffer_load_dwordx4 v[116:119], v203, s[48:51], s72 offen sc1
buffer_load_dwordx4 v[120:123], v203, s[48:51], s73 offen sc1
buffer_load_dwordx4 v[124:127], v204, s[48:51], 0 offen sc1
s_sleep 3
s_waitcnt vmcnt(4)
v_msad_u8 v207, v108, s56, 0
v_msad_u8 v208, v109, s57, 0
v_msad_u8 v207, v110, s58, v207
v_msad_u8 v208, v111, s59, v208
v_or_b32 v207, v207, v208
v_msad_u8 v14, v96, s56, 0
v_msad_u8 v15, v97, s57, 0
v_msad_u8 v14, v98, s58, v14
v_msad_u8 v15, v99, s59, v15
v_msad_u8 v14, v100, s56, v14
v_msad_u8 v15, v101, s57, v15
v_msad_u8 v14, v102, s58, v14
v_msad_u8 v15, v103, s59, v15
v_msad_u8 v14, v104, s56, v14
v_msad_u8 v15, v105, s57, v15
v_msad_u8 v14, v106, s58, v14
v_msad_u8 v15, v107, s59, v15
v_or_b32 v14, v14, v15
v_cndmask_b32 v207, 0, v207, s[60:61]
v_or_b32 v14, v14, v207
v_cmp_ne_u32 vcc, 0, v14
s_cbranch_vccz L_rdok0
buffer_load_dwordx4 v[96:99], v203, s[48:51], 0 offen sc1
buffer_load_dwordx4 v[100:103], v203, s[48:51], s72 offen sc1
buffer_load_dwordx4 v[104:107], v203, s[48:51], s73 offen sc1
buffer_load_dwordx4 v[108:111], v204, s[48:51], 0 offen sc1
s_sleep 3
s_waitcnt vmcnt(4)
v_msad_u8 v207, v124, s56, 0
v_msad_u8 v208, v125, s57, 0
v_msad_u8 v207, v126, s58, v207
v_msad_u8 v208, v127, s59, v208
v_or_b32 v207, v207, v208
v_msad_u8 v14, v112, s56, 0
v_msad_u8 v15, v113, s57, 0
v_msad_u8 v14, v114, s58, v14
v_msad_u8 v15, v115, s59, v15
v_msad_u8 v14, v116, s56, v14
v_msad_u8 v15, v117, s57, v15
v_msad_u8 v14, v118, s58, v14
v_msad_u8 v15, v119, s59, v15
v_msad_u8 v14, v120, s56, v14
v_msad_u8 v15, v121, s57, v15
v_msad_u8 v14, v122, s58, v14
v_msad_u8 v15, v123, s59, v15
v_or_b32 v14, v14, v15
v_cndmask_b32 v207, 0, v207, s[60:61]
v_or_b32 v14, v14, v207
v_cmp_ne_u32 vcc, 0, v14
s_cbranch_vccz L_rdok1
s_sub_u32 s80, s80, 1
s_cbranch_scc0 L_rd
s_mov_b32 s80, 0
L_rdok1:
v_and_b32 v112, 0xffffff00, v112
v_and_b32 v113, 0xffffff00, v113
v_and_b32 v114, 0xffffff00, v114
v_and_b32 v115, 0xffffff00, v115
v_and_b32 v116, 0xffffff00, v116
v_and_b32 v117, 0xffffff00, v117
v_and_b32 v118, 0xffffff00, v118
v_and_b32 v119, 0xffffff00, v119
v_and_b32 v120, 0xffffff00, v120
v_and_b32 v121, 0xffffff00, v121
v_and_b32 v122, 0xffffff00, v122
v_and_b32 v123, 0xffffff00, v123
v_and_b32 v124, 0xffffff00, v124
v_and_b32 v125, 0xffffff00, v125
v_and_b32 v126, 0xffffff00, v126
v_and_b32 v127, 0xffffff00, v127
v_pk_add_f32 v[212:213], v[112:113], v[116:117]
v_pk_add_f32 v[220:221], v[120:121], v[124:125]
v_pk_add_f32 v[214:215], v[114:115], v[118:119]
v_pk_add_f32 v[222:223], v[122:123], v[126:127]
s_branch L_rdj
L_rdok0:
v_and_b32 v96, 0xffffff00, v96
v_and_b32 v97, 0xffffff00, v97
v_and_b32 v98, 0xffffff00, v98
v_and_b32 v99, 0xffffff00, v99
v_and_b32 v100, 0xffffff00, v100
v_and_b32 v101, 0xffffff00, v101
v_and_b32 v102, 0xffffff00, v102
v_and_b32 v103, 0xffffff00, v103
v_and_b32 v104, 0xffffff00, v104
v_and_b32 v105, 0xffffff00, v105
v_and_b32 v106, 0xffffff00, v106
v_and_b32 v107, 0xffffff00, v107
v_and_b32 v108, 0xffffff00, v108
v_and_b32 v109, 0xffffff00, v109
v_and_b32 v110, 0xffffff00, v110
v_and_b32 v111, 0xffffff00, v111
v_pk_add_f32 v[212:213], v[96:97], v[100:101]
v_pk_add_f32 v[220:221], v[104:105], v[108:109]
v_pk_add_f32 v[214:215], v[98:99], v[102:103]
v_pk_add_f32 v[222:223], v[106:107], v[110:111]
L_rdj:
v_pk_add_f32 v[212:213], v[212:213], v[220:221]
v_pk_add_f32 v[214:215], v[214:215], v[222:223]
s_nop 0
v_permlane32_swap_b32 v212, v213
v_permlane32_swap_b32 v214, v215
v_add_f32 v212, v212, v213
v_add_f32 v214, v214, v215
s_nop 1
v_permlane16_swap_b32 v212, v214
v_add_f32 v212, v212, v214
s_nop 1
v_add_f32_dpp v212, v212, v212 row_ror:8 row_mask:0xf bank_mask:0xf
v_cvt_pk_bf16_f32 v212, v212, v212
v_and_b32 v212, s81, v212
v_add_f32 v212, v212, v206
v_cvt_pk_bf16_f32 v212, v212, v212
buffer_store_short v212, v205, s[52:55], 0 offen
s_branch L_aux_end
L_ld_f:
s_mov_b32 s32, s16
s_mov_b32 s33, s17
s_mov_b32 s34, 2211840
s_mov_b32 s35, 0x20000
s_mov_b32 s36, s18
s_mov_b32 s37, s19
s_mov_b32 s38, 2211840
s_mov_b32 s39, 0x20000
s_mov_b32 s60, 3456
s_mov_b32 s61, 6912
s_mov_b32 s62, 10368
s_mov_b32 s63, 13824
s_mov_b32 s64, 17280
s_mov_b32 s65, 20736
s_mov_b32 s66, 24192
s_mov_b32 s67, 27648
s_mov_b32 s68, 31104
s_lshl_b32 s72, s77, 7
v_mul_u32_u24 v250, 3456, v12
v_lshl_add_u32 v250, v3, 4, v250
v_add_u32 v250, s72, v250
v_bfe_u32 v14, v0, 4, 1
v_bfe_u32 v15, v0, 2, 1
v_lshl_add_u32 v14, v14, 1, v15
v_bfe_u32 v15, v0, 3, 1
v_lshl_add_u32 v14, v14, 1, v15
v_lshrrev_b32 v15, 5, v0
v_lshl_add_u32 v14, v14, 1, v15
s_mul_i32 s72, s3, 80
v_mad_u32_u24 v111, v14, 5, s72
v_lshlrev_b32 v14, 1, v111
buffer_load_ushort v96, v14, s[28:31], 0 offen offset:0
buffer_load_ushort v97, v14, s[28:31], 0 offen offset:2
buffer_load_ushort v98, v14, s[28:31], 0 offen offset:4
buffer_load_ushort v99, v14, s[28:31], 0 offen offset:6
buffer_load_ushort v100, v14, s[28:31], 0 offen offset:8
buffer_load_dwordx4 v[16:19], v250, s[32:35], 0 offen nt
buffer_load_dwordx4 v[24:27], v250, s[36:39], 0 offen nt
buffer_load_dwordx4 v[32:35], v250, s[32:35], s60 offen nt
buffer_load_dwordx4 v[40:43], v250, s[36:39], s60 offen nt
buffer_load_dwordx4 v[48:51], v250, s[32:35], s61 offen nt
buffer_load_dwordx4 v[56:59], v250, s[36:39], s61 offen nt
buffer_load_dwordx4 v[64:67], v250, s[32:35], s62 offen nt
buffer_load_dwordx4 v[72:75], v250, s[36:39], s62 offen nt
buffer_load_dwordx4 v[80:83], v250, s[32:35], s63 offen nt
buffer_load_dwordx4 v[88:91], v250, s[36:39], s63 offen nt
buffer_load_dwordx4 v[20:23], v250, s[32:35], s64 offen nt
buffer_load_dwordx4 v[28:31], v250, s[36:39], s64 offen nt
buffer_load_dwordx4 v[36:39], v250, s[32:35], s65 offen nt
buffer_load_dwordx4 v[44:47], v250, s[36:39], s65 offen nt
buffer_load_dwordx4 v[52:55], v250, s[32:35], s66 offen nt
buffer_load_dwordx4 v[60:63], v250, s[36:39], s66 offen nt
buffer_load_dwordx4 v[68:71], v250, s[32:35], s67 offen nt
buffer_load_dwordx4 v[76:79], v250, s[36:39], s67 offen nt
buffer_load_dwordx4 v[84:87], v250, s[32:35], s68 offen nt
buffer_load_dwordx4 v[92:95], v250, s[36:39], s68 offen nt
s_barrier
s_mov_b32 s44, s20
s_mov_b32 s45, s21
s_mov_b32 s46, 2211840
s_mov_b32 s47, 0x20000
s_lshl_b32 s72, s77, 3
s_add_u32 s72, s72, s3
s_mul_i32 s72, s72, 10240
v_lshrrev_b32 v14, 4, v0
v_mul_u32_u24 v14, 1280, v14
v_and_b32 v15, 15, v0
v_lshl_add_u32 v14, v15, 4, v14
v_add_u32 v14, s72, v14
s_mov_b32 s69, 5120
v_mov_b32 v110, v14
buffer_load_dwordx4 v[160:163], v110, s[44:47], 0 offen offset:0 nt
buffer_load_dwordx4 v[164:167], v110, s[44:47], s69 offen offset:0 nt
buffer_load_dwordx4 v[168:171], v110, s[44:47], 0 offen offset:256 nt
buffer_load_dwordx4 v[172:175], v110, s[44:47], s69 offen offset:256 nt
buffer_load_dwordx4 v[176:179], v110, s[44:47], 0 offen offset:512 nt
buffer_load_dwordx4 v[180:183], v110, s[44:47], s69 offen offset:512 nt
buffer_load_dwordx4 v[184:187], v110, s[44:47], 0 offen offset:768 nt
buffer_load_dwordx4 v[188:191], v110, s[44:47], s69 offen offset:768 nt
buffer_load_dwordx4 v[192:195], v110, s[44:47], 0 offen offset:1024 nt
buffer_load_dwordx4 v[196:199], v110, s[44:47], s69 offen offset:1024 nt
L_ffn:
v_and_b32 v14, 15, v0
v_lshrrev_b32 v15, 4, v0
v_lshlrev_b32 v14, 5, v14
v_lshl_add_u32 v14, v15, 4, v14
s_mul_i32 s72, s3, 2688
s_add_u32 s72, s72, 20992
v_add_u32 v14, s72, v14
v_lshlrev_b32 v15, 4, v0
v_add_u32 v15, 42496, v15
v_cmp_gt_u32 vcc, 32, v0
s_nop 1
v_cndmask_b32 v250, v15, v14, vcc
v_lshrrev_b32 v14, 1, v0
v_lshlrev_b32 v14, 4, v14
s_lshl_b32 s72, s3, 9
v_add_u32 v14, s72, v14
v_and_b32 v15, 1, v0
v_cmp_eq_u32 vcc, 0, v15
v_mul_u32_u24 v15, 2688, v15
v_add_u32 v251, v14, v15
s_mul_i32 s72, s77, 2560
s_add_u32 s72, s72, 98432
v_add_u32 v14, s72, v14
v_mov_b32 v15, 2147483648
v_cndmask_b32 v201, v15, v14, vcc
s_mov_b32 s82, 0x3f803f80
v_lshrrev_b32 v14, 2, v0
v_mov_b32 v14, v111
v_add_u32 v15, 0, v14
v_and_b32 v15, 3, v15
v_lshlrev_b32 v15, 3, v15
v_bfe_u32 v101, s93, v15, 8
v_add_u32 v15, 1, v14
v_and_b32 v15, 3, v15
v_lshlrev_b32 v15, 3, v15
v_bfe_u32 v102, s93, v15, 8
v_add_u32 v15, 2, v14
v_and_b32 v15, 3, v15
v_lshlrev_b32 v15, 3, v15
v_bfe_u32 v103, s93, v15, 8
v_add_u32 v15, 3, v14
v_and_b32 v15, 3, v15
v_lshlrev_b32 v15, 3, v15
v_bfe_u32 v104, s93, v15, 8
s_and_b32 s72, s2, 0
s_mul_i32 s72, s72, 10240
s_add_u32 s72, s72, 1161216
v_and_b32 v15, 3, v0
v_mul_u32_u24 v15, 2560, v15
v_add_u32 v15, s72, v15
v_lshl_add_u32 v107, v111, 2, v15
v_lshlrev_b32 v109, 3, v3
s_lshl_b32 s72, s3, 3
v_mov_b32 v14, s72
v_lshlrev_b32 v15, 4, v0
v_add_u32 v15, 42496, v15
v_cmp_eq_u32 vcc, 63, v0
s_nop 1
v_cndmask_b32 v108, v15, v14, vcc
v_and_b32 v228, s82, v8
v_and_b32 v229, s82, v9
v_and_b32 v230, s82, v8
v_and_b32 v231, s82, v9
v_mov_b32 v204, 0
v_mov_b32 v205, 0
v_mov_b32 v206, 0
v_mov_b32 v207, 0
v_mov_b32 v208, 0
v_mov_b32 v209, 0
v_mov_b32 v210, 0
v_mov_b32 v211, 0
v_mov_b32 v124, 0
v_mov_b32 v125, 0
v_mov_b32 v126, 0
v_mov_b32 v127, 0
v_mov_b32 v128, 0
v_mov_b32 v129, 0
v_mov_b32 v130, 0
v_mov_b32 v131, 0
v_mov_b32 v132, 0
v_mov_b32 v133, 0
v_mov_b32 v134, 0
v_mov_b32 v135, 0
v_mov_b32 v136, 0
v_mov_b32 v137, 0
v_mov_b32 v138, 0
v_mov_b32 v139, 0
v_mov_b32 v140, 0
v_mov_b32 v141, 0
v_mov_b32 v142, 0
v_mov_b32 v143, 0
s_waitcnt vmcnt(10)
v_lshlrev_b32 v96, 16, v96
v_lshlrev_b32 v97, 16, v97
v_lshlrev_b32 v98, 16, v98
v_lshlrev_b32 v99, 16, v99
v_lshlrev_b32 v100, 16, v100
v_smfmac_f32_16x16x64_bf16 v[204:207], v[228:231], v[16:23], v10
v_smfmac_f32_16x16x64_bf16 v[208:211], v[228:231], v[24:31], v10
v_smfmac_f32_16x16x64_bf16 v[204:207], v[228:231], v[32:39], v10
v_smfmac_f32_16x16x64_bf16 v[208:211], v[228:231], v[40:47], v10
v_smfmac_f32_16x16x64_bf16 v[204:207], v[228:231], v[48:55], v10
v_smfmac_f32_16x16x64_bf16 v[208:211], v[228:231], v[56:63], v10
v_smfmac_f32_16x16x64_bf16 v[204:207], v[228:231], v[64:71], v10
v_smfmac_f32_16x16x64_bf16 v[208:211], v[228:231], v[72:79], v10
v_smfmac_f32_16x16x64_bf16 v[204:207], v[228:231], v[80:87], v10
v_smfmac_f32_16x16x64_bf16 v[208:211], v[228:231], v[88:95], v10
s_nop 6
ds_write_b128 v243, v[204:207]
ds_write_b128 v243, v[208:211] offset:256
s_waitcnt lgkmcnt(0)
s_barrier
ds_read2st64_b32 v[204:205], v244 offset0:0 offset1:17
ds_read2st64_b32 v[206:207], v244 offset0:1 offset1:18
s_waitcnt lgkmcnt(1)
v_add_f32 v204, v204, v205
s_waitcnt lgkmcnt(0)
v_add_f32 v206, v206, v207
v_add_f32_dpp v204, v204, v204 quad_perm:[1,0,3,2] row_mask:0xf bank_mask:0xf
s_nop 0
v_add_f32_dpp v206, v206, v206 quad_perm:[1,0,3,2] row_mask:0xf bank_mask:0xf
v_add_f32_dpp v204, v204, v204 quad_perm:[2,3,0,1] row_mask:0xf bank_mask:0xf
s_nop 0
v_add_f32_dpp v206, v206, v206 quad_perm:[2,3,0,1] row_mask:0xf bank_mask:0xf
v_add_f32_dpp v204, v204, v204 row_half_mirror row_mask:0xf bank_mask:0xf
s_nop 0
v_add_f32_dpp v206, v206, v206 row_half_mirror row_mask:0xf bank_mask:0xf
v_mov_b32 v105, v204
v_mov_b32 v106, v206
v_mov_b32 v204, 0
v_mov_b32 v205, 0
v_mov_b32 v206, 0
v_mov_b32 v207, 0
v_mov_b32 v208, 0
v_mov_b32 v209, 0
v_mov_b32 v210, 0
v_mov_b32 v211, 0
s_barrier
buffer_load_dwordx4 v[112:115], v107, s[48:51], 0 offen sc1
buffer_load_dword v116, v107, s[48:51], 0 offen offset:16 sc1
s_sleep 3
L_h2:
buffer_load_dwordx4 v[118:121], v107, s[48:51], 0 offen sc1
buffer_load_dword v122, v107, s[48:51], 0 offen offset:16 sc1
s_sleep 3
s_waitcnt vmcnt(2)
v_msad_u8 v14, v112, v101, 0
v_msad_u8 v15, v113, v102, 0
v_msad_u8 v14, v114, v103, v14
v_msad_u8 v15, v115, v104, v15
v_msad_u8 v14, v116, v101, v14
v_or_b32 v14, v14, v15
v_cmp_ne_u32 vcc, 0, v14
s_cbranch_vccz L_h2ok0
buffer_load_dwordx4 v[112:115], v107, s[48:51], 0 offen sc1
buffer_load_dword v116, v107, s[48:51], 0 offen offset:16 sc1
s_sleep 3
s_waitcnt vmcnt(2)
v_msad_u8 v14, v118, v101, 0
v_msad_u8 v15, v119, v102, 0
v_msad_u8 v14, v120, v103, v14
v_msad_u8 v15, v121, v104, v15
v_msad_u8 v14, v122, v101, v14
v_or_b32 v14, v14, v15
v_cmp_ne_u32 vcc, 0, v14
s_cbranch_vccz L_h2ok1
s_sub_u32 s80, s80, 1
s_cbranch_scc0 L_h2
s_mov_b32 s80, 0
L_h2ok1:
v_and_b32 v118, 0xffffff00, v118
v_and_b32 v119, 0xffffff00, v119
v_and_b32 v120, 0xffffff00, v120
v_and_b32 v121, 0xffffff00, v121
v_and_b32 v122, 0xffffff00, v122
v_add_f32_dpp v212, v118, v118 quad_perm:[1,0,3,2] row_mask:0xf bank_mask:0xf
v_add_f32_dpp v213, v119, v119 quad_perm:[1,0,3,2] row_mask:0xf bank_mask:0xf
v_add_f32_dpp v214, v120, v120 quad_perm:[1,0,3,2] row_mask:0xf bank_mask:0xf
v_add_f32_dpp v215, v121, v121 quad_perm:[1,0,3,2] row_mask:0xf bank_mask:0xf
v_add_f32_dpp v216, v122, v122 quad_perm:[1,0,3,2] row_mask:0xf bank_mask:0xf
s_branch L_h2j
L_h2ok0:
v_and_b32 v112, 0xffffff00, v112
v_and_b32 v113, 0xffffff00, v113
v_and_b32 v114, 0xffffff00, v114
v_and_b32 v115, 0xffffff00, v115
v_and_b32 v116, 0xffffff00, v116
v_add_f32_dpp v212, v112, v112 quad_perm:[1,0,3,2] row_mask:0xf bank_mask:0xf
v_add_f32_dpp v213, v113, v113 quad_perm:[1,0,3,2] row_mask:0xf bank_mask:0xf
v_add_f32_dpp v214, v114, v114 quad_perm:[1,0,3,2] row_mask:0xf bank_mask:0xf
v_add_f32_dpp v215, v115, v115 quad_perm:[1,0,3,2] row_mask:0xf bank_mask:0xf
v_add_f32_dpp v216, v116, v116 quad_perm:[1,0,3,2] row_mask:0xf bank_mask:0xf
L_h2j:
v_add_f32_dpp v212, v212, v212 quad_perm:[2,3,0,1] row_mask:0xf bank_mask:0xf
v_add_f32_dpp v213, v213, v213 quad_perm:[2,3,0,1] row_mask:0xf bank_mask:0xf
v_add_f32_dpp v214, v214, v214 quad_perm:[2,3,0,1] row_mask:0xf bank_mask:0xf
v_add_f32_dpp v215, v215, v215 quad_perm:[2,3,0,1] row_mask:0xf bank_mask:0xf
v_add_f32_dpp v216, v216, v216 quad_perm:[2,3,0,1] row_mask:0xf bank_mask:0xf
v_cvt_pk_bf16_f32 v218, v212, v213
v_cvt_pk_bf16_f32 v219, v214, v215
v_cvt_pk_bf16_f32 v216, v216, v216
v_lshlrev_b32 v212, 16, v218
v_and_b32 v213, s81, v218
v_lshlrev_b32 v214, 16, v219
v_and_b32 v215, s81, v219
v_and_b32 v216, s81, v216
v_add_f32 v212, v212, v96
v_add_f32 v213, v213, v97
v_add_f32 v214, v214, v98
v_add_f32 v215, v215, v99
v_add_f32 v216, v216, v100
v_cvt_pk_bf16_f32 v220, v212, v212
v_cvt_pk_bf16_f32 v221, v213, v213
v_cvt_pk_bf16_f32 v222, v214, v214
v_cvt_pk_bf16_f32 v223, v215, v215
v_cvt_pk_bf16_f32 v224, v216, v216
v_and_b32 v228, v220, v8
v_and_b32_dpp v229, v220, v9 row_half_mirror row_mask:0xf bank_mask:0xf
v_and_b32_dpp v230, v220, v8 row_half_mirror row_mask:0xf bank_mask:0xf
v_and_b32 v231, v220, v9
v_and_b32 v232, v221, v8
v_and_b32_dpp v233, v221, v9 row_half_mirror row_mask:0xf bank_mask:0xf
v_and_b32_dpp v234, v221, v8 row_half_mirror row_mask:0xf bank_mask:0xf
v_and_b32 v235, v221, v9
v_smfmac_f32_16x16x64_bf16 v[204:207], v[228:231], v[16:23], v10
v_smfmac_f32_16x16x64_bf16 v[208:211], v[228:231], v[24:31], v10
v_dot2_f32_bf16 v226, v220, s82, 0
v_dot2_f32_bf16 v227, v220, v220, 0
v_dot2_f32_bf16 v226, v221, s82, v226
v_dot2_f32_bf16 v227, v221, v221, v227
v_and_b32 v236, v222, v8
v_and_b32_dpp v237, v222, v9 row_half_mirror row_mask:0xf bank_mask:0xf
v_and_b32_dpp v238, v222, v8 row_half_mirror row_mask:0xf bank_mask:0xf
v_and_b32 v239, v222, v9
v_smfmac_f32_16x16x64_bf16 v[204:207], v[232:235], v[32:39], v10
v_smfmac_f32_16x16x64_bf16 v[208:211], v[232:235], v[40:47], v10
v_dot2_f32_bf16 v226, v222, s82, v226
v_dot2_f32_bf16 v227, v222, v222, v227
v_dot2_f32_bf16 v226, v223, s82, v226
v_dot2_f32_bf16 v227, v223, v223, v227
v_and_b32 v228, v223, v8
v_and_b32_dpp v229, v223, v9 row_half_mirror row_mask:0xf bank_mask:0xf
v_and_b32_dpp v230, v223, v8 row_half_mirror row_mask:0xf bank_mask:0xf
v_and_b32 v231, v223, v9
v_smfmac_f32_16x16x64_bf16 v[204:207], v[236:239], v[48:55], v10
v_smfmac_f32_16x16x64_bf16 v[208:211], v[236:239], v[56:63], v10
v_dot2_f32_bf16 v226, v224, s82, v226
v_dot2_f32_bf16 v227, v224, v224, v227
s_nop 1
v_add_f32_dpp v226, v226, v226 row_half_mirror row_mask:0xf bank_mask:0xf
v_add_f32_dpp v227, v227, v227 row_half_mirror row_mask:0xf bank_mask:0xf
v_and_b32 v232, v224, v8
v_and_b32_dpp v233, v224, v9 row_half_mirror row_mask:0xf bank_mask:0xf
v_and_b32_dpp v234, v224, v8 row_half_mirror row_mask:0xf bank_mask:0xf
v_and_b32 v235, v224, v9
v_smfmac_f32_16x16x64_bf16 v[204:207], v[228:231], v[64:71], v10
v_smfmac_f32_16x16x64_bf16 v[208:211], v[228:231], v[72:79], v10
v_add_f32_dpp v226, v226, v226 row_mirror row_mask:0xf bank_mask:0xf
v_add_f32_dpp v227, v227, v227 row_mirror row_mask:0xf bank_mask:0xf
s_nop 0
v_add_f32_dpp v226, v226, v226 row_bcast:15 row_mask:0xa bank_mask:0xf
v_add_f32_dpp v227, v227, v227 row_bcast:15 row_mask:0xa bank_mask:0xf
v_smfmac_f32_16x16x64_bf16 v[204:207], v[232:235], v[80:87], v10
v_smfmac_f32_16x16x64_bf16 v[208:211], v[232:235], v[88:95], v10
v_add_f32_dpp v226, v226, v226 row_bcast:31 row_mask:0xc bank_mask:0xf
v_add_f32_dpp v227, v227, v227 row_bcast:31 row_mask:0xc bank_mask:0xf
ds_write_b64 v108, v[226:227]
s_nop 3
ds_write_b128 v243, v[204:207]
ds_write_b128 v243, v[208:211] offset:256
s_waitcnt lgkmcnt(0)
s_barrier
ds_read_b64 v[212:213], v109
ds_read2st64_b32 v[204:205], v244 offset0:0 offset1:17
ds_read2st64_b32 v[206:207], v244 offset0:1 offset1:18
s_waitcnt lgkmcnt(2)
v_add_f32_dpp v212, v212, v212 quad_perm:[1,0,3,2] row_mask:0xf bank_mask:0xf
v_add_f32_dpp v213, v213, v213 quad_perm:[1,0,3,2] row_mask:0xf bank_mask:0xf
s_nop 0
v_add_f32_dpp v212, v212, v212 quad_perm:[2,3,0,1] row_mask:0xf bank_mask:0xf
v_add_f32_dpp v213, v213, v213 quad_perm:[2,3,0,1] row_mask:0xf bank_mask:0xf
s_nop 0
v_add_f32_dpp v212, v212, v212 row_half_mirror row_mask:0xf bank_mask:0xf
v_add_f32_dpp v213, v213, v213 row_half_mirror row_mask:0xf bank_mask:0xf
v_mul_f32 v212, 0x3a4ccccd, v212
v_mul_f32 v213, 0x3a4ccccd, v213
s_waitcnt lgkmcnt(0)
v_fma_f32 v213, -v212, v212, v213
v_add_f32 v204, v204, v205
v_max_f32 v213, 0, v213
v_add_f32 v206, v206, v207
v_cvt_pk_bf16_f32 v212, v212, v213
v_add_f32_dpp v204, v204, v204 quad_perm:[1,0,3,2] row_mask:0xf bank_mask:0xf
v_and_b32 v213, s81, v212
v_add_f32_dpp v206, v206, v206 quad_perm:[1,0,3,2] row_mask:0xf bank_mask:0xf
v_add_f32 v213, 0x3727c5ac, v213
v_add_f32_dpp v204, v204, v204 quad_perm:[2,3,0,1] row_mask:0xf bank_mask:0xf
v_cvt_pk_bf16_f32 v213, v213, v213
v_add_f32_dpp v206, v206, v206 quad_perm:[2,3,0,1] row_mask:0xf bank_mask:0xf
v_and_b32 v213, s81, v213
v_add_f32_dpp v204, v204, v204 row_half_mirror row_mask:0xf bank_mask:0xf
v_sqrt_f32 v213, v213
v_add_f32_dpp v206, v206, v206 row_half_mirror row_mask:0xf bank_mask:0xf
v_lshlrev_b32 v212, 16, v212
v_cvt_pk_bf16_f32 v213, v213, v213
v_fma_f32 v204, -v212, v105, v204
v_and_b32 v213, s81, v213
v_fma_f32 v206, -v212, v106, v206
v_rcp_f32 v213, v213
s_nop 0
v_mul_f32 v204, v204, v213
v_mul_f32 v206, v206, v213
v_cvt_pk_bf16_f32 v204, v204, v206
v_lshlrev_b32 v205, 16, v204
v_and_b32 v206, s81, v204
v_mul_f32 v207, v205, v205
v_fmaak_f32 v207, v207, v249, 0xc0135761
v_mul_f32 v207, v207, v205
v_exp_f32 v207, v207
s_nop 0
v_add_f32 v207, 1.0, v207
v_rcp_f32 v207, v207
s_nop 0
v_mul_f32 v207, v207, v205
v_cvt_pk_bf16_f32 v207, v207, v207
v_and_b32 v207, s81, v207
v_mul_f32 v207, v207, v206
v_cvt_pk_bf16_f32 v207, v207, v207
s_nop 1
v_and_b32_dpp v228, v207, v8 row_newbcast:0 row_mask:0xf bank_mask:0xf
v_and_b32_dpp v229, v207, v9 row_newbcast:0 row_mask:0xf bank_mask:0xf
v_and_b32_dpp v230, v207, v8 row_newbcast:8 row_mask:0xf bank_mask:0xf
v_and_b32_dpp v231, v207, v9 row_newbcast:8 row_mask:0xf bank_mask:0xf
s_nop 1
v_smfmac_f32_16x16x64_bf16 v[124:127], v[228:231], v[160:167], v10
v_smfmac_f32_16x16x64_bf16 v[128:131], v[228:231], v[168:175], v10
v_smfmac_f32_16x16x64_bf16 v[132:135], v[228:231], v[176:183], v10
v_smfmac_f32_16x16x64_bf16 v[136:139], v[228:231], v[184:191], v10
v_smfmac_f32_16x16x64_bf16 v[140:143], v[228:231], v[192:199], v10
s_nop 3
ds_write_b128 v250, v[124:127] offset:0
ds_write_b128 v250, v[128:131] offset:512
ds_write_b128 v250, v[132:135] offset:1024
ds_write_b128 v250, v[136:139] offset:1536
ds_write_b128 v250, v[140:143] offset:2048
s_waitcnt lgkmcnt(0)
s_barrier
s_cmp_ge_u32 s3, 5
s_cbranch_scc1 L_aux_end
ds_read_b128 v[212:215], v251 offset:20992
ds_read_b128 v[216:219], v251 offset:26368
ds_read_b128 v[220:223], v251 offset:31744
ds_read_b128 v[224:227], v251 offset:37120
v_mov_b32 v14, 0xff
s_waitcnt lgkmcnt(2)
v_pk_add_f32 v[212:213], v[212:213], v[216:217]
v_pk_add_f32 v[214:215], v[214:215], v[218:219]
s_waitcnt lgkmcnt(0)
v_pk_add_f32 v[220:221], v[220:221], v[224:225]
v_pk_add_f32 v[222:223], v[222:223], v[226:227]
v_pk_add_f32 v[212:213], v[212:213], v[220:221]
v_pk_add_f32 v[214:215], v[214:215], v[222:223]
s_nop 0
v_add_f32_dpp v212, v212, v212 quad_perm:[1,0,3,2] row_mask:0xf bank_mask:0xf
v_add_f32_dpp v213, v213, v213 quad_perm:[1,0,3,2] row_mask:0xf bank_mask:0xf
v_add_f32_dpp v214, v214, v214 quad_perm:[1,0,3,2] row_mask:0xf bank_mask:0xf
v_add_f32_dpp v215, v215, v215 quad_perm:[1,0,3,2] row_mask:0xf bank_mask:0xf
v_bfi_b32 v212, v14, s56, v212
v_bfi_b32 v213, v14, s57, v213
v_bfi_b32 v214, v14, s58, v214
v_bfi_b32 v215, v14, s59, v215
buffer_store_dwordx4 v[212:215], v201, s[48:51], 0 offen sc1
L_aux_end:
s_endpgm
.section .rodata,"a"
.p2align 6
.amdhsa_kernel sequential_preLN__gqa_block_cached__glu_gated_geglu__decode_kernel
  .amdhsa_next_free_vgpr 256
  .amdhsa_next_free_sgpr 102
  .amdhsa_accum_offset 256
  .amdhsa_group_segment_fixed_size 0
  .amdhsa_kernarg_size 96
  .amdhsa_user_sgpr_count 2
  .amdhsa_user_sgpr_kernarg_segment_ptr 1
  .amdhsa_system_sgpr_workgroup_id_x 1
.end_amdhsa_kernel
```
